```python
import torch

def _softmax(x, axis=-1):
    return torch.softmax(x, dim=axis)
def _gelu(x):
    return torch.nn.functional.gelu(x, approximate="tanh")
def _silu(x):
    return torch.nn.functional.silu(x)
def _sigmoid(x):
    return torch.sigmoid(x)
def _layernorm(x, axis=-1, eps=1e-5):
    m = x.mean(dim=axis, keepdim=True)
    v = x.var(dim=axis, keepdim=True, unbiased=False)
    return (x - m) / torch.sqrt(v + eps)
def _scatter_add(tgt, idx, src, axis=0):
    return tgt.clone().index_add_(axis, idx, src)
def _segment_sum(src, seg, n):
    out = torch.zeros((n,) + src.shape[1:], dtype=src.dtype)
    return out.index_add_(0, seg, src)
def _pad(x, pw):
    flat = tuple(v for pair in reversed(pw) for v in pair)
    return torch.nn.functional.pad(x, flat)

kernel_name = 'recurrent_scan__ssm_conv_h3__mixer_token_mlp__prompt'

def setup_inputs():

    _w = (lambda a: (lambda t: t.to(torch.bfloat16) if t.is_floating_point() else t)(torch.as_tensor(a)))
    def _A_setup():
        B, S, D = 1, 2048, 448
        ks = 4
        return {
            "q": _w((lambda *s: torch.randn(*s, dtype=torch.bfloat16) * 0.05)(B, S, D)),
            "k": _w((lambda *s: torch.randn(*s, dtype=torch.bfloat16) * 0.8)(B, S, D)),
            "v": _w((lambda *s: torch.randn(*s, dtype=torch.bfloat16) * 0.8)(B, S, D)),
            "shift_k": _w((lambda *s: torch.randn(*s, dtype=torch.bfloat16) * 0.8)(D, ks) * 0.5),
            "ssm_k": _w((lambda *s: torch.randn(*s, dtype=torch.bfloat16) * 0.8)(D, S) * (1.0 / S ** 0.5)),
            "ssm_D": _w((lambda *s: torch.randn(*s, dtype=torch.bfloat16) * 0.8)(D)),
        }
    _A_in = _A_setup()

    def _B_setup():
        B, S, D, F = 1, 2048, 448, 1792
        return {
            "x": _w((lambda *s: torch.randn(*s, dtype=torch.bfloat16) * 0.05)(B, S, D)),
            "w1": _w((lambda *s: torch.randn(*s, dtype=torch.bfloat16) * 0.8)(S, F) * (S ** -0.5)),
            "b1": _w((lambda *s: torch.randn(*s, dtype=torch.bfloat16) * 12.8)(F) * 0.02),
            "w2": _w((lambda *s: torch.randn(*s, dtype=torch.bfloat16) * 0.2)(F, S) * (F ** -0.5)),
            "b2": _w((lambda *s: torch.randn(*s, dtype=torch.bfloat16) * 1.6)(S) * 0.02),
        }
    _B_in = _B_setup()

    return {
        "A_q": _A_in["q"],
        "A_k": _A_in["k"],
        "A_v": _A_in["v"],
        "A_shift_k": _A_in["shift_k"],
        "A_ssm_k": _A_in["ssm_k"],
        "A_ssm_D": _A_in["ssm_D"],
        "B_x": _B_in["x"],
        "B_w1": _B_in["w1"],
        "B_b1": _B_in["b1"],
        "B_w2": _B_in["w2"],
        "B_b2": _B_in["b2"],
    }

def reference(A_q, A_k, A_v, A_shift_k, A_ssm_k, A_ssm_D, B_x, B_w1, B_b1, B_w2, B_b2):
    def _A_ref(q, k, v, shift_k, ssm_k, ssm_D):
        B, S, D = q.shape
        ks = shift_k.shape[-1]
        k_pad = _pad(k, ((0, 0), (ks - 1, 0), (0, 0)))
        k_shift = torch.zeros_like(k)
        for t in range(ks):
            k_shift = k_shift + k_pad[:, t:t + S, :] * shift_k[:, ks - 1 - t][None, None, :]
        kv = k_shift * v
        L = 2 * S
        kv_pad = _pad(kv, ((0, 0), (0, S), (0, 0)))
        kf_pad = _pad(ssm_k, ((0, 0), (0, S)))
        kv_f = (lambda x, axes=(-2,-1): torch.fft.rfft2(x.float(), dim=axes))(kv_pad[:, None, :, :], axes=(1, 2))
        kf_f = (lambda x, axes=(-2,-1): torch.fft.rfft2(x.float(), dim=axes))(kf_pad[:, None, :], axes=(1, 2))
        kf_f = (lambda x, *d: x.permute(*d))(kf_f, 1, 2, 0)
        y_f = kv_f * kf_f[None, :, :, :]
        y = (lambda x, s, axes=(-2,-1): torch.fft.irfft2(x, s=s, dim=axes).to(torch.bfloat16))(y_f, (1, L), axes=(1, 2))[:, 0, :S, :]
        y = y + kv * ssm_D[None, None, :]
        return q * y

    def _B_ref(x, w1, b1, w2, b2):
        B, S, D = x.shape
        h = _layernorm(x, axis=-1)
        u = torch.einsum("bsd,sf->bdf", h, w1) + b1
        u = _gelu(u)
        y = torch.einsum("bdf,fs->bds", u, w2) + b2
        return (lambda x, *d: x.permute(*d))(y, 0, 2, 1)

    x = A_q
    xn = _layernorm(x, axis=-1)
    s = _A_ref(xn, A_k, A_v, A_shift_k, A_ssm_k, A_ssm_D)
    g = _silu(_B_ref(xn, B_w1, B_b1, B_w2, B_b2))
    return x + s * g
```

```asm
; @launch grid=(256,1,1) block=(256,1,1) lds=150016
.amdgcn_target "amdgcn-amd-amdhsa--gfx950"
.text
.globl recurrent_scan__ssm_conv_h3__mixer_token_mlp__prompt_kernel
.p2align 8
.type recurrent_scan__ssm_conv_h3__mixer_token_mlp__prompt_kernel,@function
recurrent_scan__ssm_conv_h3__mixer_token_mlp__prompt_kernel:
KSTART:
  s_cmp_ge_u32 s2, 256
  s_cbranch_scc1 Kend
  s_load_dwordx16 s[4:19], s[0:1], 0
  s_load_dwordx8 s[20:27], s[0:1], 64
  s_load_dwordx4 s[28:31], s[0:1], 96
  v_and_b32 v1, 63, v0
  v_lshrrev_b32 v2, 6, v0
  s_getpc_b64 s[36:37]
PC0:
  v_readfirstlane_b32 s80, v2
  v_lshlrev_b32 v2, 4, v1
  s_sub_u32 s36, s36, PC0-KSTART
  s_subb_u32 s37, s37, 0
  s_and_b32 s37, s37, 0xffff
  s_mov_b32 s38, KEND-KSTART
  s_mov_b32 s39, 0x20000
  s_lshr_b32 s61, s2, 3
  s_lshl_b32 s40, s61, 2
  s_add_u32 s40, s40, s80
  s_lshl_b32 s40, s40, 8
  v_lshlrev_b32 v246, 7, v1
  s_mov_b64 exec, 0xffff
  buffer_load_dword v241, v246, s[36:39], s40 offen
  s_mov_b64 exec, -1
  v_cmp_gt_u32 vcc, 56, v1
  v_mov_b32 v9, 0x80000000
  s_lshl_b32 s3, s2, 3
  s_lshl_b32 s41, s80, 1
  v_cndmask_b32 v9, v9, v2, vcc
  v_mov_b32 v31, 0
  s_add_u32 s3, s3, s41
  s_mul_i32 s41, s3, 896
  s_mov_b32 s42, 8716288
  s_and_b32 s60, s2, 7
  s_mul_i32 s62, s61, 37
  s_lshr_b32 s62, s62, 8
  s_mul_i32 s63, s62, 7
  s_sub_u32 s63, s61, s63
  s_mov_b32 s83, s63
  s_lshl_b32 s64, s62, 3
  s_add_u32 s84, s64, s60
  s_and_b32 s65, s60, 1
  s_lshl_b32 s66, s65, 2
  s_add_u32 s66, s66, s63
  s_lshr_b32 s67, s60, 1
  s_add_u32 s67, s67, 24
  s_cmp_lt_u32 s61, 21
  s_cselect_b32 s81, s63, s66
  s_cselect_b32 s82, s84, s67
  s_sub_u32 s68, 25, s65
  s_cmp_lt_u32 s61, s68
  s_cselect_b32 s86, 1, 0
  v_lshrrev_b32 v16, 3, v1
  v_and_b32 v17, 7, v1
  v_bfe_u32 v18, v1, 4, 1
  v_lshlrev_b32 v18, 1, v18
  v_xor_b32 v17, v17, v18
  v_lshlrev_b32 v17, 4, v17
  v_mul_u32_u24 v16, 3584, v16
  v_add_u32 v172, v16, v17
  v_xor_b32 v17, 64, v17
  v_add_u32 v16, v16, v17
  v_add_u32 v173, 27648, v16
  v_add_u32 v174, 55296, v172
  v_add_u32 v175, 82944, v16
  s_mul_i32 s97, s80, 1835008
  s_lshl_b32 s96, s82, 7
  s_add_u32 s97, s97, s96
  s_add_u32 s95, s97, 1835008
  s_mul_i32 s96, s81, 229376
  s_add_u32 s97, s97, s96
  s_mul_i32 s96, s80, 24576
  s_add_u32 s96, s96, 51712
  s_waitcnt lgkmcnt(0)
  s_mov_b32 s32, s4
  s_and_b32 s33, s5, 0xffff
  s_mov_b32 s34, 1835008
  s_mov_b32 s35, 0x20000
  buffer_load_dwordx4 v[32:35], v9, s[32:35], s41 offen
  buffer_load_dwordx4 v[64:67], v9, s[32:35], s41 offen offset:896
  s_mov_b32 s76, s30
  s_and_b32 s77, s31, 0xffff
  s_mov_b32 s78, 16777216
  s_mov_b32 s79, 0x20000
  buffer_load_dword v247, v31, s[76:79], s42 offen sc1
  s_mov_b32 s56, s18
  s_and_b32 s57, s19, 0xffff
  s_mov_b32 s58, 7340032
  s_mov_b32 s59, 0x20000
  s_cmp_eq_u32 s86, 0
  s_cbranch_scc1 L1
  s_add_u32 m0, s96, 0
  s_nop 0
  buffer_load_dwordx4 v172, s[56:59], s97 offen offset:0 lds
  buffer_load_dwordx4 v173, s[56:59], s97 offen offset:1024 lds
  buffer_load_dwordx4 v174, s[56:59], s97 offen offset:2048 lds
  buffer_load_dwordx4 v175, s[56:59], s97 offen offset:3072 lds
  s_add_u32 s97, s97, 114688
  s_add_u32 m0, s96, 4096
  s_nop 0
  buffer_load_dwordx4 v172, s[56:59], s97 offen offset:0 lds
  buffer_load_dwordx4 v173, s[56:59], s97 offen offset:1024 lds
  buffer_load_dwordx4 v174, s[56:59], s97 offen offset:2048 lds
  buffer_load_dwordx4 v175, s[56:59], s97 offen offset:3072 lds
  s_add_u32 s97, s97, 114688
  s_cmp_eq_u32 s97, s95
  s_cselect_b32 s100, 1835008, 0
  s_sub_u32 s97, s97, s100
L1:
  s_cmp_lt_u32 s61, 28
  s_cselect_b32 s87, 1, 0
  s_sub_u32 s64, s61, 28
  s_sub_u32 s66, s61, s68
  s_add_u32 s66, s66, 4
  s_cmp_ge_u32 s61, 28
  s_cselect_b32 s98, s64, s66
  s_mov_b32 s36, s6
  s_and_b32 s37, s7, 0xffff
  s_mov_b32 s38, 1835008
  s_mov_b32 s39, 0x20000
  s_mov_b32 s40, s8
  s_and_b32 s41, s9, 0xffff
  s_mov_b32 s42, 1835008
  s_mov_b32 s43, 0x20000
  s_mov_b32 s44, s10
  s_and_b32 s45, s11, 0xffff
  s_mov_b32 s46, 3584
  s_mov_b32 s47, 0x20000
  s_mov_b32 s48, s12
  s_and_b32 s49, s13, 0xffff
  s_mov_b32 s50, 1835008
  s_mov_b32 s51, 0x20000
  s_mov_b32 s52, s14
  s_and_b32 s53, s15, 0xffff
  s_mov_b32 s54, 896
  s_mov_b32 s55, 0x20000
  v_and_b32 v19, 7, v0
  v_lshrrev_b32 v18, 3, v0
  v_lshlrev_b32 v20, 6, v19
  v_lshlrev_b32 v19, 4, v19
  v_mul_u32_u24 v21, 1792, v18
  v_add_u32 v21, v21, v19
  s_and_b32 s12, s2, 7
  s_mul_i32 s8, s12, 57344
  s_lshl_b32 s9, s98, 7
  s_add_u32 s8, s8, s9
  v_add_u32 v21, s8, v21
  v_mul_u32_u24 v22, 288, v18
  v_add_u32 v22, v22, v19
  v_add_u32 v22, 51712, v22
  v_lshrrev_b32 v24, 4, v1
  v_bfe_u32 v18, v1, 1, 1
  v_lshl_add_u32 v18, v18, 2, v24
  v_bfe_u32 v23, v1, 2, 2
  v_lshl_add_u32 v23, v18, 3, v23
  v_sub_u32 v23, 59, v23
  v_mul_u32_u24 v23, 144, v23
  v_and_b32 v18, 1, v1
  v_lshlrev_b32 v18, 3, v18
  s_lshl_b32 s8, s80, 5
  s_add_u32 s8, s8, 51712
  v_add3_u32 v23, v23, v18, s8
  v_bfe_u32 v18, v1, 3, 1
  v_lshl_add_u32 v24, v18, 2, v24
  v_and_b32 v18, 7, v1
  v_mul_u32_u24 v18, 4096, v18
  v_lshl_add_u32 v24, v24, 4, v18
  v_add_u32 v27, 32768, v24
  s_lshl_b32 s13, s98, 2
  s_add_u32 s13, s13, s80
  s_mul_i32 s13, s13, 65536
  s_lshl_b32 s8, s12, 7
  s_sub_u32 s13, s13, s8
  s_add_u32 s13, s13, 4198272
  s_lshl_b32 s14, s98, 5
  s_add_u32 s14, s14, s12
  s_lshl_b32 s15, s98, 9
  s_cmp_eq_u32 s86, 0
  s_cbranch_scc0 L2
  v_subrev_u32 v18, 2688, v21
  buffer_load_dwordx4 v[96:99], v18, s[36:39], 0 offen
  v_subrev_u32 v18, 1792, v21
  buffer_load_dwordx4 v[100:103], v18, s[36:39], 0 offen
  v_subrev_u32 v18, 896, v21
  buffer_load_dwordx4 v[104:107], v18, s[36:39], 0 offen
  v_add_u32 v18, 0, v21
  buffer_load_dwordx4 v[108:111], v18, s[36:39], 0 offen
  buffer_load_dwordx4 v[116:119], v18, s[40:43], 0 offen
  v_add_u32 v18, 896, v21
  buffer_load_dwordx4 v[112:115], v18, s[36:39], 0 offen
  buffer_load_dwordx4 v[120:123], v18, s[40:43], 0 offen
  buffer_load_dwordx4 v[180:183], v20, s[44:47], s15 offen offset:0
  buffer_load_dwordx4 v[184:187], v20, s[44:47], s15 offen offset:16
  buffer_load_dwordx4 v[188:191], v20, s[44:47], s15 offen offset:32
  buffer_load_dwordx4 v[192:195], v20, s[44:47], s15 offen offset:48
L2:
  s_mov_b32 s60, s20
  s_and_b32 s61, s21, 0xffff
  s_mov_b32 s62, 3584
  s_mov_b32 s63, 0x20000
  s_mov_b32 s64, s22
  s_and_b32 s65, s23, 0xffff
  s_mov_b32 s66, 7340032
  s_mov_b32 s67, 0x20000
  s_mov_b32 s68, s24
  s_and_b32 s69, s25, 0xffff
  s_mov_b32 s70, 4096
  s_mov_b32 s71, 0x20000
  s_mov_b32 s72, s26
  s_and_b32 s73, s27, 0xffff
  s_mov_b32 s74, 1835008
  s_mov_b32 s75, 0x20000
  v_cndmask_b32 v10, 0, 1.0, vcc
  v_mov_b32 v11, 0x3b124925
  v_lshrrev_b32 v16, 4, v1
  v_bfe_u32 v17, v1, 2, 2
  v_and_b32 v18, 3, v1
  v_lshlrev_b32 v19, 10, v16
  v_lshl_add_u32 v19, v17, 7, v19
  v_lshl_add_u32 v19, v18, 3, v19
  s_mul_i32 s8, s80, 24576
  s_add_u32 s8, s8, 51712
  v_add_u32 v19, s8, v19
  v_lshrrev_b32 v17, 1, v17
  v_and_b32 v16, 1, v16
  v_lshl_add_u32 v16, v16, 1, v17
  s_add_u32 s8, s80, 1
  s_and_b32 s8, s8, 3
  v_xor_b32 v17, s8, v16
  v_lshl_add_u32 v5, v17, 5, v19
  s_add_u32 s8, s80, 2
  s_and_b32 s8, s8, 3
  v_xor_b32 v17, s8, v16
  v_lshl_add_u32 v6, v17, 5, v19
  s_add_u32 s8, s80, 3
  s_and_b32 s8, s8, 3
  v_xor_b32 v17, s8, v16
  v_lshl_add_u32 v7, v17, 5, v19
  s_add_u32 s8, s80, 4
  s_and_b32 s8, s8, 3
  v_xor_b32 v17, s8, v16
  v_lshl_add_u32 v8, v17, 5, v19
  s_lshl_b32 s6, s80, 1
  s_mul_i32 s6, s6, 1040
  s_add_u32 s6, s6, 33280
  v_add_u32 v12, s6, v2
  v_bfe_u32 v13, v1, 2, 2
  v_mul_u32_u24 v13, 1040, v13
  v_lshrrev_b32 v14, 4, v1
  v_lshl_add_u32 v13, v14, 5, v13
  v_and_b32 v15, 3, v1
  v_lshl_add_u32 v13, v15, 3, v13
  s_lshl_b32 s6, s80, 7
  s_add_u32 s6, s6, 33280
  v_add_u32 v13, s6, v13
  v_lshlrev_b32 v14, 10, v14
  v_and_b32 v15, 15, v1
  v_lshl_add_u32 v14, v15, 4, v14
  s_lshr_b32 s6, s2, 2
  s_lshl_b32 s7, s80, 6
  s_add_u32 s6, s6, s7
  s_lshl_b32 s6, s6, 12
  s_and_b32 s7, s2, 3
  s_lshl_b32 s7, s7, 8
  s_add_u32 s6, s6, s7
  s_add_u32 s7, s6, 1048576
  s_cmp_eq_u32 s80, 3
  s_cselect_b32 s7, 1073741824, s7
  s_lshl_b32 s5, s3, 3
  s_add_u32 s5, s5, 8388608
  s_lshr_b32 s92, s2, 3
  s_lshl_b32 s92, s92, 2
  s_add_u32 s92, s92, s80
  s_mul_i32 s92, s92, 22
  v_add_u32 v244, s92, v1
  s_and_b32 s93, s2, 7
  s_and_b32 s99, s2, 1
  v_and_b32 v245, 63, v244
  v_bfe_u32 v246, v244, 6, 2
  v_lshl_add_u32 v245, v246, 9, v245
  v_add_u32 v245, 448, v245
  v_lshrrev_b32 v246, 8, v244
  v_lshl_add_u32 v246, v246, 3, s93
  v_subrev_u32 v243, 768, v244
  v_and_b32 v242, 255, v243
  v_bfe_u32 v240, v243, 8, 2
  v_lshl_add_u32 v242, v240, 9, v242
  s_xor_b32 s92, s99, 1
  s_lshl_b32 s92, s92, 8
  v_add_u32 v242, s92, v242
  v_and_b32 v240, 63, v243
  v_bfe_u32 v239, v243, 6, 2
  v_lshl_add_u32 v240, v239, 9, v240
  v_add_u32 v240, 448, v240
  v_cmp_gt_u32 vcc, 1792, v244
  s_nop 1
  v_cndmask_b32 v242, v240, v242, vcc
  s_lshr_b32 s93, s93, 1
  s_add_u32 s93, s93, 24
  v_mov_b32 v240, s93
  v_cmp_gt_u32 vcc, 768, v244
  s_nop 1
  v_cndmask_b32 v245, v242, v245, vcc
  v_cndmask_b32 v246, v240, v246, vcc
  v_mul_u32_u24 v245, 3584, v245
  v_lshl_add_u32 v246, v246, 7, v245
  s_lshl_b32 s92, s99, 8
  s_add_u32 s92, s92, 1792
  v_cmp_gt_u32 vcc, s92, v244
  v_cmp_gt_u32 s[92:93], 22, v1
  s_nop 0
  s_and_b64 vcc, vcc, s[92:93]
  v_mov_b32 v245, 0x80000000
  v_cndmask_b32 v246, v245, v246, vcc
  s_cmp_eq_u32 s86, 0
  s_cbranch_scc0 L3
  s_waitcnt vmcnt(11)
  s_branch L3x
L3:
  s_waitcnt vmcnt(8)
L3x:
  buffer_load_dword v26, v246, s[56:59], 0 offen
  v_readfirstlane_b32 s85, v247
  s_nop 0
  s_mul_i32 s85, s85, 0x9E3779B1
  s_add_u32 s85, s85, 0x7F4A7C15
  v_lshlrev_b32 v36, 16, v32
  v_lshlrev_b32 v68, 16, v64
  v_and_b32 v37, 0xffff0000, v32
  v_and_b32 v69, 0xffff0000, v64
  v_lshlrev_b32 v38, 16, v33
  v_lshlrev_b32 v70, 16, v65
  v_and_b32 v39, 0xffff0000, v33
  v_and_b32 v71, 0xffff0000, v65
  v_lshlrev_b32 v40, 16, v34
  v_lshlrev_b32 v72, 16, v66
  v_and_b32 v41, 0xffff0000, v34
  v_and_b32 v73, 0xffff0000, v66
  v_lshlrev_b32 v42, 16, v35
  v_lshlrev_b32 v74, 16, v67
  v_and_b32 v43, 0xffff0000, v35
  v_and_b32 v75, 0xffff0000, v67
  v_pk_add_f32 v[52:53], v[36:37], v[38:39]
  v_pk_add_f32 v[84:85], v[68:69], v[70:71]
  v_pk_add_f32 v[54:55], v[40:41], v[42:43]
  v_pk_add_f32 v[86:87], v[72:73], v[74:75]
  v_pk_add_f32 v[52:53], v[52:53], v[54:55]
  v_pk_add_f32 v[84:85], v[84:85], v[86:87]
  v_add_f32 v52, v52, v53
  v_add_f32 v84, v84, v85
  s_nop 0
  v_add_f32_dpp v52, v52, v52 row_shr:1 row_mask:0xf bank_mask:0xf
  v_add_f32_dpp v84, v84, v84 row_shr:1 row_mask:0xf bank_mask:0xf
  s_nop 0
  v_add_f32_dpp v52, v52, v52 row_shr:2 row_mask:0xf bank_mask:0xf
  v_add_f32_dpp v84, v84, v84 row_shr:2 row_mask:0xf bank_mask:0xf
  s_nop 0
  v_add_f32_dpp v52, v52, v52 row_shr:4 row_mask:0xf bank_mask:0xf
  v_add_f32_dpp v84, v84, v84 row_shr:4 row_mask:0xf bank_mask:0xf
  s_nop 0
  v_add_f32_dpp v52, v52, v52 row_shr:8 row_mask:0xf bank_mask:0xf
  v_add_f32_dpp v84, v84, v84 row_shr:8 row_mask:0xf bank_mask:0xf
  s_nop 0
  v_add_f32_dpp v52, v52, v52 row_bcast:15 row_mask:0xa bank_mask:0xf
  v_add_f32_dpp v84, v84, v84 row_bcast:15 row_mask:0xa bank_mask:0xf
  s_nop 0
  v_add_f32_dpp v52, v52, v52 row_bcast:31 row_mask:0xc bank_mask:0xf
  v_add_f32_dpp v84, v84, v84 row_bcast:31 row_mask:0xc bank_mask:0xf
  v_readlane_b32 s8, v52, 63
  v_readlane_b32 s9, v84, 63
  s_nop 0
  v_mul_f32 v56, s8, v11
  v_mul_f32 v88, s9, v11
  v_pk_add_f32 v[44:45], v[36:37], v[56:57] op_sel_hi:[1,0] neg_lo:[0,1] neg_hi:[0,1]
  v_pk_add_f32 v[76:77], v[68:69], v[88:89] op_sel_hi:[1,0] neg_lo:[0,1] neg_hi:[0,1]
  v_pk_add_f32 v[46:47], v[38:39], v[56:57] op_sel_hi:[1,0] neg_lo:[0,1] neg_hi:[0,1]
  v_pk_add_f32 v[78:79], v[70:71], v[88:89] op_sel_hi:[1,0] neg_lo:[0,1] neg_hi:[0,1]
  v_pk_add_f32 v[48:49], v[40:41], v[56:57] op_sel_hi:[1,0] neg_lo:[0,1] neg_hi:[0,1]
  v_pk_add_f32 v[80:81], v[72:73], v[88:89] op_sel_hi:[1,0] neg_lo:[0,1] neg_hi:[0,1]
  v_pk_add_f32 v[50:51], v[42:43], v[56:57] op_sel_hi:[1,0] neg_lo:[0,1] neg_hi:[0,1]
  v_pk_add_f32 v[82:83], v[74:75], v[88:89] op_sel_hi:[1,0] neg_lo:[0,1] neg_hi:[0,1]
  v_pk_mul_f32 v[52:53], v[44:45], v[44:45]
  v_pk_mul_f32 v[84:85], v[76:77], v[76:77]
  v_pk_fma_f32 v[52:53], v[46:47], v[46:47], v[52:53]
  v_pk_fma_f32 v[84:85], v[78:79], v[78:79], v[84:85]
  v_pk_fma_f32 v[52:53], v[48:49], v[48:49], v[52:53]
  v_pk_fma_f32 v[84:85], v[80:81], v[80:81], v[84:85]
  v_pk_fma_f32 v[52:53], v[50:51], v[50:51], v[52:53]
  v_pk_fma_f32 v[84:85], v[82:83], v[82:83], v[84:85]
  v_add_f32 v52, v52, v53
  v_add_f32 v84, v84, v85
  v_mul_f32 v52, v52, v10
  v_mul_f32 v84, v84, v10
  s_nop 0
  v_add_f32_dpp v52, v52, v52 row_shr:1 row_mask:0xf bank_mask:0xf
  v_add_f32_dpp v84, v84, v84 row_shr:1 row_mask:0xf bank_mask:0xf
  s_nop 0
  v_add_f32_dpp v52, v52, v52 row_shr:2 row_mask:0xf bank_mask:0xf
  v_add_f32_dpp v84, v84, v84 row_shr:2 row_mask:0xf bank_mask:0xf
  s_nop 0
  v_add_f32_dpp v52, v52, v52 row_shr:4 row_mask:0xf bank_mask:0xf
  v_add_f32_dpp v84, v84, v84 row_shr:4 row_mask:0xf bank_mask:0xf
  s_nop 0
  v_add_f32_dpp v52, v52, v52 row_shr:8 row_mask:0xf bank_mask:0xf
  v_add_f32_dpp v84, v84, v84 row_shr:8 row_mask:0xf bank_mask:0xf
  s_nop 0
  v_add_f32_dpp v52, v52, v52 row_bcast:15 row_mask:0xa bank_mask:0xf
  v_add_f32_dpp v84, v84, v84 row_bcast:15 row_mask:0xa bank_mask:0xf
  s_nop 0
  v_add_f32_dpp v52, v52, v52 row_bcast:31 row_mask:0xc bank_mask:0xf
  v_add_f32_dpp v84, v84, v84 row_bcast:31 row_mask:0xc bank_mask:0xf
  v_readlane_b32 s8, v52, 63
  v_readlane_b32 s9, v84, 63
  s_nop 0
  v_mul_f32 v60, s8, v11
  v_mul_f32 v92, s9, v11
  v_cvt_pk_bf16_f32 v56, 0, v56
  v_cvt_pk_bf16_f32 v88, 0, v88
  v_cvt_pk_bf16_f32 v60, 0, v60
  v_cvt_pk_bf16_f32 v92, 0, v92
  v_add_f32 v60, 0x3727c5ac, v60
  v_add_f32 v92, 0x3727c5ac, v92
  v_cvt_pk_bf16_f32 v60, 0, v60
  v_cvt_pk_bf16_f32 v92, 0, v92
  v_sqrt_f32 v60, v60
  v_sqrt_f32 v92, v92
  v_pk_add_f32 v[44:45], v[36:37], v[56:57] op_sel_hi:[1,0] neg_lo:[0,1] neg_hi:[0,1]
  v_pk_add_f32 v[76:77], v[68:69], v[88:89] op_sel_hi:[1,0] neg_lo:[0,1] neg_hi:[0,1]
  v_pk_add_f32 v[46:47], v[38:39], v[56:57] op_sel_hi:[1,0] neg_lo:[0,1] neg_hi:[0,1]
  v_pk_add_f32 v[78:79], v[70:71], v[88:89] op_sel_hi:[1,0] neg_lo:[0,1] neg_hi:[0,1]
  v_pk_add_f32 v[48:49], v[40:41], v[56:57] op_sel_hi:[1,0] neg_lo:[0,1] neg_hi:[0,1]
  v_pk_add_f32 v[80:81], v[72:73], v[88:89] op_sel_hi:[1,0] neg_lo:[0,1] neg_hi:[0,1]
  v_pk_add_f32 v[50:51], v[42:43], v[56:57] op_sel_hi:[1,0] neg_lo:[0,1] neg_hi:[0,1]
  v_pk_add_f32 v[82:83], v[74:75], v[88:89] op_sel_hi:[1,0] neg_lo:[0,1] neg_hi:[0,1]
  v_cvt_pk_bf16_f32 v60, 0, v60
  v_cvt_pk_bf16_f32 v92, 0, v92
  v_rcp_f32 v58, v60
  v_rcp_f32 v90, v92
  v_cvt_pk_bf16_f32 v44, 0, v44
  v_cvt_pk_bf16_f32 v76, 0, v76
  v_cvt_pk_bf16_f32 v45, 0, v45
  v_cvt_pk_bf16_f32 v77, 0, v77
  v_cvt_pk_bf16_f32 v46, 0, v46
  v_cvt_pk_bf16_f32 v78, 0, v78
  v_cvt_pk_bf16_f32 v47, 0, v47
  v_cvt_pk_bf16_f32 v79, 0, v79
  v_cvt_pk_bf16_f32 v48, 0, v48
  v_cvt_pk_bf16_f32 v80, 0, v80
  v_cvt_pk_bf16_f32 v49, 0, v49
  v_cvt_pk_bf16_f32 v81, 0, v81
  v_cvt_pk_bf16_f32 v50, 0, v50
  v_cvt_pk_bf16_f32 v82, 0, v82
  v_cvt_pk_bf16_f32 v51, 0, v51
  v_cvt_pk_bf16_f32 v83, 0, v83
  v_pk_mul_f32 v[36:37], v[44:45], v[58:59] op_sel_hi:[1,0]
  v_pk_mul_f32 v[68:69], v[76:77], v[90:91] op_sel_hi:[1,0]
  v_pk_mul_f32 v[38:39], v[46:47], v[58:59] op_sel_hi:[1,0]
  v_pk_mul_f32 v[70:71], v[78:79], v[90:91] op_sel_hi:[1,0]
  v_pk_mul_f32 v[40:41], v[48:49], v[58:59] op_sel_hi:[1,0]
  v_pk_mul_f32 v[72:73], v[80:81], v[90:91] op_sel_hi:[1,0]
  v_pk_mul_f32 v[42:43], v[50:51], v[58:59] op_sel_hi:[1,0]
  v_pk_mul_f32 v[74:75], v[82:83], v[90:91] op_sel_hi:[1,0]
  v_cvt_pk_bf16_f32 v36, 0, v36
  v_cvt_pk_bf16_f32 v68, 0, v68
  v_cvt_pk_bf16_f32 v37, 0, v37
  v_cvt_pk_bf16_f32 v69, 0, v69
  v_cvt_pk_bf16_f32 v38, 0, v38
  v_cvt_pk_bf16_f32 v70, 0, v70
  v_cvt_pk_bf16_f32 v39, 0, v39
  v_cvt_pk_bf16_f32 v71, 0, v71
  v_cvt_pk_bf16_f32 v40, 0, v40
  v_cvt_pk_bf16_f32 v72, 0, v72
  v_cvt_pk_bf16_f32 v41, 0, v41
  v_cvt_pk_bf16_f32 v73, 0, v73
  v_cvt_pk_bf16_f32 v42, 0, v42
  v_cvt_pk_bf16_f32 v74, 0, v74
  v_cvt_pk_bf16_f32 v43, 0, v43
  v_cvt_pk_bf16_f32 v75, 0, v75
  v_mov_b32 v62, v56
  v_mov_b32 v94, v88
  v_mov_b32 v63, v58
  v_mov_b32 v95, v90
  v_pk_add_f32 v[52:53], v[36:37], v[38:39]
  v_pk_add_f32 v[84:85], v[68:69], v[70:71]
  v_pk_add_f32 v[54:55], v[40:41], v[42:43]
  v_pk_add_f32 v[86:87], v[72:73], v[74:75]
  v_pk_add_f32 v[52:53], v[52:53], v[54:55]
  v_pk_add_f32 v[84:85], v[84:85], v[86:87]
  v_add_f32 v52, v52, v53
  v_add_f32 v84, v84, v85
  v_mul_f32 v52, v52, v10
  v_mul_f32 v84, v84, v10
  s_nop 0
  v_add_f32_dpp v52, v52, v52 row_shr:1 row_mask:0xf bank_mask:0xf
  v_add_f32_dpp v84, v84, v84 row_shr:1 row_mask:0xf bank_mask:0xf
  s_nop 0
  v_add_f32_dpp v52, v52, v52 row_shr:2 row_mask:0xf bank_mask:0xf
  v_add_f32_dpp v84, v84, v84 row_shr:2 row_mask:0xf bank_mask:0xf
  s_nop 0
  v_add_f32_dpp v52, v52, v52 row_shr:4 row_mask:0xf bank_mask:0xf
  v_add_f32_dpp v84, v84, v84 row_shr:4 row_mask:0xf bank_mask:0xf
  s_nop 0
  v_add_f32_dpp v52, v52, v52 row_shr:8 row_mask:0xf bank_mask:0xf
  v_add_f32_dpp v84, v84, v84 row_shr:8 row_mask:0xf bank_mask:0xf
  s_nop 0
  v_add_f32_dpp v52, v52, v52 row_bcast:15 row_mask:0xa bank_mask:0xf
  v_add_f32_dpp v84, v84, v84 row_bcast:15 row_mask:0xa bank_mask:0xf
  s_nop 0
  v_add_f32_dpp v52, v52, v52 row_bcast:31 row_mask:0xc bank_mask:0xf
  v_add_f32_dpp v84, v84, v84 row_bcast:31 row_mask:0xc bank_mask:0xf
  v_readlane_b32 s8, v52, 63
  v_readlane_b32 s9, v84, 63
  s_nop 0
  v_mul_f32 v56, s8, v11
  v_mul_f32 v88, s9, v11
  v_pk_add_f32 v[44:45], v[36:37], v[56:57] op_sel_hi:[1,0] neg_lo:[0,1] neg_hi:[0,1]
  v_pk_add_f32 v[76:77], v[68:69], v[88:89] op_sel_hi:[1,0] neg_lo:[0,1] neg_hi:[0,1]
  v_pk_add_f32 v[46:47], v[38:39], v[56:57] op_sel_hi:[1,0] neg_lo:[0,1] neg_hi:[0,1]
  v_pk_add_f32 v[78:79], v[70:71], v[88:89] op_sel_hi:[1,0] neg_lo:[0,1] neg_hi:[0,1]
  v_pk_add_f32 v[48:49], v[40:41], v[56:57] op_sel_hi:[1,0] neg_lo:[0,1] neg_hi:[0,1]
  v_pk_add_f32 v[80:81], v[72:73], v[88:89] op_sel_hi:[1,0] neg_lo:[0,1] neg_hi:[0,1]
  v_pk_add_f32 v[50:51], v[42:43], v[56:57] op_sel_hi:[1,0] neg_lo:[0,1] neg_hi:[0,1]
  v_pk_add_f32 v[82:83], v[74:75], v[88:89] op_sel_hi:[1,0] neg_lo:[0,1] neg_hi:[0,1]
  v_pk_mul_f32 v[52:53], v[44:45], v[44:45]
  v_pk_mul_f32 v[84:85], v[76:77], v[76:77]
  v_pk_fma_f32 v[52:53], v[46:47], v[46:47], v[52:53]
  v_pk_fma_f32 v[84:85], v[78:79], v[78:79], v[84:85]
  v_pk_fma_f32 v[52:53], v[48:49], v[48:49], v[52:53]
  v_pk_fma_f32 v[84:85], v[80:81], v[80:81], v[84:85]
  v_pk_fma_f32 v[52:53], v[50:51], v[50:51], v[52:53]
  v_pk_fma_f32 v[84:85], v[82:83], v[82:83], v[84:85]
  v_add_f32 v52, v52, v53
  v_add_f32 v84, v84, v85
  v_mul_f32 v52, v52, v10
  v_mul_f32 v84, v84, v10
  s_nop 0
  v_add_f32_dpp v52, v52, v52 row_shr:1 row_mask:0xf bank_mask:0xf
  v_add_f32_dpp v84, v84, v84 row_shr:1 row_mask:0xf bank_mask:0xf
  s_nop 0
  v_add_f32_dpp v52, v52, v52 row_shr:2 row_mask:0xf bank_mask:0xf
  v_add_f32_dpp v84, v84, v84 row_shr:2 row_mask:0xf bank_mask:0xf
  s_nop 0
  v_add_f32_dpp v52, v52, v52 row_shr:4 row_mask:0xf bank_mask:0xf
  v_add_f32_dpp v84, v84, v84 row_shr:4 row_mask:0xf bank_mask:0xf
  s_nop 0
  v_add_f32_dpp v52, v52, v52 row_shr:8 row_mask:0xf bank_mask:0xf
  v_add_f32_dpp v84, v84, v84 row_shr:8 row_mask:0xf bank_mask:0xf
  s_nop 0
  v_add_f32_dpp v52, v52, v52 row_bcast:15 row_mask:0xa bank_mask:0xf
  v_add_f32_dpp v84, v84, v84 row_bcast:15 row_mask:0xa bank_mask:0xf
  s_nop 0
  v_add_f32_dpp v52, v52, v52 row_bcast:31 row_mask:0xc bank_mask:0xf
  v_add_f32_dpp v84, v84, v84 row_bcast:31 row_mask:0xc bank_mask:0xf
  v_readlane_b32 s8, v52, 63
  v_readlane_b32 s9, v84, 63
  s_nop 0
  v_mul_f32 v60, s8, v11
  v_mul_f32 v92, s9, v11
  v_cvt_pk_bf16_f32 v56, 0, v56
  v_cvt_pk_bf16_f32 v88, 0, v88
  v_cvt_pk_bf16_f32 v60, 0, v60
  v_cvt_pk_bf16_f32 v92, 0, v92
  v_add_f32 v60, 0x3727c5ac, v60
  v_add_f32 v92, 0x3727c5ac, v92
  v_cvt_pk_bf16_f32 v60, 0, v60
  v_cvt_pk_bf16_f32 v92, 0, v92
  v_sqrt_f32 v60, v60
  v_sqrt_f32 v92, v92
  v_pk_add_f32 v[44:45], v[36:37], v[56:57] op_sel_hi:[1,0] neg_lo:[0,1] neg_hi:[0,1]
  v_pk_add_f32 v[76:77], v[68:69], v[88:89] op_sel_hi:[1,0] neg_lo:[0,1] neg_hi:[0,1]
  v_pk_add_f32 v[46:47], v[38:39], v[56:57] op_sel_hi:[1,0] neg_lo:[0,1] neg_hi:[0,1]
  v_pk_add_f32 v[78:79], v[70:71], v[88:89] op_sel_hi:[1,0] neg_lo:[0,1] neg_hi:[0,1]
  v_pk_add_f32 v[48:49], v[40:41], v[56:57] op_sel_hi:[1,0] neg_lo:[0,1] neg_hi:[0,1]
  v_pk_add_f32 v[80:81], v[72:73], v[88:89] op_sel_hi:[1,0] neg_lo:[0,1] neg_hi:[0,1]
  v_pk_add_f32 v[50:51], v[42:43], v[56:57] op_sel_hi:[1,0] neg_lo:[0,1] neg_hi:[0,1]
  v_pk_add_f32 v[82:83], v[74:75], v[88:89] op_sel_hi:[1,0] neg_lo:[0,1] neg_hi:[0,1]
  v_cvt_pk_bf16_f32 v60, 0, v60
  v_cvt_pk_bf16_f32 v92, 0, v92
  v_rcp_f32 v58, v60
  v_rcp_f32 v90, v92
  v_cvt_pk_bf16_f32 v44, 0, v44
  v_cvt_pk_bf16_f32 v76, 0, v76
  v_cvt_pk_bf16_f32 v45, 0, v45
  v_cvt_pk_bf16_f32 v77, 0, v77
  v_cvt_pk_bf16_f32 v46, 0, v46
  v_cvt_pk_bf16_f32 v78, 0, v78
  v_cvt_pk_bf16_f32 v47, 0, v47
  v_cvt_pk_bf16_f32 v79, 0, v79
  v_cvt_pk_bf16_f32 v48, 0, v48
  v_cvt_pk_bf16_f32 v80, 0, v80
  v_cvt_pk_bf16_f32 v49, 0, v49
  v_cvt_pk_bf16_f32 v81, 0, v81
  v_cvt_pk_bf16_f32 v50, 0, v50
  v_cvt_pk_bf16_f32 v82, 0, v82
  v_cvt_pk_bf16_f32 v51, 0, v51
  v_cvt_pk_bf16_f32 v83, 0, v83
  v_pk_mul_f32 v[36:37], v[44:45], v[58:59] op_sel_hi:[1,0]
  v_pk_mul_f32 v[68:69], v[76:77], v[90:91] op_sel_hi:[1,0]
  v_pk_mul_f32 v[38:39], v[46:47], v[58:59] op_sel_hi:[1,0]
  v_pk_mul_f32 v[70:71], v[78:79], v[90:91] op_sel_hi:[1,0]
  v_pk_mul_f32 v[40:41], v[48:49], v[58:59] op_sel_hi:[1,0]
  v_pk_mul_f32 v[72:73], v[80:81], v[90:91] op_sel_hi:[1,0]
  v_pk_mul_f32 v[42:43], v[50:51], v[58:59] op_sel_hi:[1,0]
  v_pk_mul_f32 v[74:75], v[82:83], v[90:91] op_sel_hi:[1,0]
  v_cvt_pk_bf16_f32 v32, v36, v37
  v_cvt_pk_bf16_f32 v64, v68, v69
  v_cvt_pk_bf16_f32 v33, v38, v39
  v_cvt_pk_bf16_f32 v65, v70, v71
  v_cvt_pk_bf16_f32 v34, v40, v41
  v_cvt_pk_bf16_f32 v66, v72, v73
  v_cvt_pk_bf16_f32 v35, v42, v43
  v_cvt_pk_bf16_f32 v67, v74, v75
  ds_write_b128 v12, v[32:35]
  ds_write_b128 v12, v[64:67] offset:1040
  v_mov_b64 v[60:61], v[94:95]
  v_mov_b64 v[58:59], v[62:63]
  s_waitcnt lgkmcnt(0)
  s_barrier
  ds_read_b64_tr_b16 v[36:37], v13
  ds_read_b64_tr_b16 v[38:39], v13 offset:4160
  ds_read_b64_tr_b16 v[40:41], v13 offset:512
  ds_read_b64_tr_b16 v[42:43], v13 offset:4672
  s_mov_b64 exec, 1
  buffer_store_dwordx4 v[58:61], v31, s[76:79], s5 offen sc1
  s_mov_b64 exec, -1
  s_waitcnt lgkmcnt(2)
  buffer_store_dwordx4 v[36:39], v14, s[76:79], s6 offen sc1
  s_waitcnt lgkmcnt(0)
  buffer_store_dwordx4 v[40:43], v14, s[76:79], s7 offen sc1
  s_cmp_eq_u32 s86, 0
  s_cbranch_scc1 ROLEBC
  s_add_u32 m0, s96, 8192
  s_nop 0
  buffer_load_dwordx4 v172, s[56:59], s97 offen offset:0 lds
  buffer_load_dwordx4 v173, s[56:59], s97 offen offset:1024 lds
  buffer_load_dwordx4 v174, s[56:59], s97 offen offset:2048 lds
  buffer_load_dwordx4 v175, s[56:59], s97 offen offset:3072 lds
  s_add_u32 s97, s97, 114688
  v_lshrrev_b32 v19, 4, v1
  v_lshlrev_b32 v19, 3, v19
  s_lshl_b32 s8, s82, 7
  s_lshl_b32 s9, s80, 5
  s_add_u32 s8, s8, s9
  buffer_load_dwordx2 v[28:29], v19, s[60:63], s8 offen
  v_bfe_u32 v9, v1, 4, 1
  v_lshlrev_b32 v9, 10, v9
  v_and_b32 v17, 15, v1
  v_lshl_add_u32 v9, v17, 4, v9
  v_lshrrev_b32 v17, 5, v1
  v_lshl_add_u32 v9, v17, 8, v9
  s_mul_i32 s17, s81, 56
  s_lshl_b32 s9, s82, 1
  s_add_u32 s17, s17, s9
  s_lshr_b32 s9, s80, 1
  s_add_u32 s17, s17, s9
  s_lshl_b32 s17, s17, 12
  s_and_b32 s9, s80, 1
  s_lshl_b32 s9, s9, 9
  s_add_u32 s17, s17, s9
  s_add_u32 s17, s17, 2097152
  s_add_u32 s8, s80, 1
  s_and_b32 s8, s8, 3
  s_mul_i32 s8, s8, 24576
  s_add_u32 s8, s8, 64000
  v_add_u32 v12, s8, v2
  s_add_u32 s8, s80, 2
  s_and_b32 s8, s8, 3
  s_mul_i32 s8, s8, 24576
  s_add_u32 s8, s8, 68096
  v_add_u32 v13, s8, v2
  s_add_u32 s8, s80, 3
  s_and_b32 s8, s8, 3
  s_mul_i32 s8, s8, 24576
  s_add_u32 s8, s8, 72192
  v_add_u32 v14, s8, v2
  s_mul_i32 s8, s80, 24576
  s_add_u32 s8, s8, 64000
  v_add_u32 v15, s8, v2
  s_lshl_b32 s16, s81, 6
  s_lshl_b32 s8, s80, 4
  s_add_u32 s16, s16, s8
  s_lshl_b32 s16, s16, 12
  s_add_u32 s16, s16, 0
  s_add_u32 s3, s16, 65536
  s_lshl_b32 s8, s81, 13
  s_add_u32 s16, s16, s8
  s_waitcnt vmcnt(5)
  s_mov_b32 s8, s2
  s_mul_i32 s8, s8, 16
  s_add_u32 s8, s8, 8454144
  s_cmp_eq_u32 s80, 0
  s_cselect_b32 s8, s8, 1073741824
  v_mov_b32 v30, s85
  v_mov_b32 v31, 0
  s_barrier
  s_mov_b64 exec, 1
  buffer_store_dword v30, v31, s[76:79], s8 offen sc1
  s_mov_b64 exec, -1
  s_add_u32 m0, s96, 12288
  s_nop 0
  buffer_load_dwordx4 v172, s[56:59], s97 offen offset:0 lds
  buffer_load_dwordx4 v173, s[56:59], s97 offen offset:1024 lds
  buffer_load_dwordx4 v174, s[56:59], s97 offen offset:2048 lds
  buffer_load_dwordx4 v175, s[56:59], s97 offen offset:3072 lds
  s_add_u32 s97, s97, 114688
  s_cmp_eq_u32 s97, s95
  s_cselect_b32 s100, 1835008, 0
  s_sub_u32 s97, s97, s100
  s_waitcnt vmcnt(18)
  ds_read_b64_tr_b16 a[0:1], v5 offset:0
  ds_read_b64_tr_b16 a[2:3], v5 offset:512
  ds_read_b64_tr_b16 a[4:5], v6 offset:0
  ds_read_b64_tr_b16 a[6:7], v6 offset:512
  ds_read_b64_tr_b16 a[8:9], v7 offset:0
  ds_read_b64_tr_b16 a[10:11], v7 offset:512
  ds_read_b64_tr_b16 a[12:13], v8 offset:0
  ds_read_b64_tr_b16 a[14:15], v8 offset:512
  s_add_u32 m0, s96, 16384
  s_nop 0
  buffer_load_dwordx4 v172, s[56:59], s97 offen offset:0 lds
  buffer_load_dwordx4 v173, s[56:59], s97 offen offset:1024 lds
  buffer_load_dwordx4 v174, s[56:59], s97 offen offset:2048 lds
  buffer_load_dwordx4 v175, s[56:59], s97 offen offset:3072 lds
  s_add_u32 s97, s97, 114688
  s_waitcnt vmcnt(18)
  ds_read_b64_tr_b16 a[16:17], v5 offset:4096
  ds_read_b64_tr_b16 a[18:19], v5 offset:4608
  ds_read_b64_tr_b16 a[20:21], v6 offset:4096
  ds_read_b64_tr_b16 a[22:23], v6 offset:4608
  ds_read_b64_tr_b16 a[24:25], v7 offset:4096
  ds_read_b64_tr_b16 a[26:27], v7 offset:4608
  ds_read_b64_tr_b16 a[28:29], v8 offset:4096
  ds_read_b64_tr_b16 a[30:31], v8 offset:4608
  s_add_u32 m0, s96, 20480
  s_nop 0
  buffer_load_dwordx4 v172, s[56:59], s97 offen offset:0 lds
  buffer_load_dwordx4 v173, s[56:59], s97 offen offset:1024 lds
  buffer_load_dwordx4 v174, s[56:59], s97 offen offset:2048 lds
  buffer_load_dwordx4 v175, s[56:59], s97 offen offset:3072 lds
  s_add_u32 s97, s97, 114688
  s_cmp_eq_u32 s97, s95
  s_cselect_b32 s100, 1835008, 0
  s_sub_u32 s97, s97, s100
  s_waitcnt vmcnt(14)
  ds_read_b64_tr_b16 a[32:33], v5 offset:8192
  ds_read_b64_tr_b16 a[34:35], v5 offset:8704
  ds_read_b64_tr_b16 a[36:37], v6 offset:8192
  ds_read_b64_tr_b16 a[38:39], v6 offset:8704
  ds_read_b64_tr_b16 a[40:41], v7 offset:8192
  ds_read_b64_tr_b16 a[42:43], v7 offset:8704
  ds_read_b64_tr_b16 a[44:45], v8 offset:8192
  ds_read_b64_tr_b16 a[46:47], v8 offset:8704
  s_waitcnt lgkmcnt(0)
  s_add_u32 m0, s96, 0
  s_nop 0
  buffer_load_dwordx4 v172, s[56:59], s97 offen offset:0 lds
  buffer_load_dwordx4 v173, s[56:59], s97 offen offset:1024 lds
  buffer_load_dwordx4 v174, s[56:59], s97 offen offset:2048 lds
  buffer_load_dwordx4 v175, s[56:59], s97 offen offset:3072 lds
  s_add_u32 s97, s97, 114688
  s_waitcnt vmcnt(12)
  ds_read_b64_tr_b16 a[48:49], v5 offset:12288
  ds_read_b64_tr_b16 a[50:51], v5 offset:12800
  ds_read_b64_tr_b16 a[52:53], v6 offset:12288
  ds_read_b64_tr_b16 a[54:55], v6 offset:12800
  ds_read_b64_tr_b16 a[56:57], v7 offset:12288
  ds_read_b64_tr_b16 a[58:59], v7 offset:12800
  ds_read_b64_tr_b16 a[60:61], v8 offset:12288
  ds_read_b64_tr_b16 a[62:63], v8 offset:12800
  s_add_u32 m0, s96, 4096
  s_nop 0
  buffer_load_dwordx4 v172, s[56:59], s97 offen offset:0 lds
  buffer_load_dwordx4 v173, s[56:59], s97 offen offset:1024 lds
  buffer_load_dwordx4 v174, s[56:59], s97 offen offset:2048 lds
  buffer_load_dwordx4 v175, s[56:59], s97 offen offset:3072 lds
  s_add_u32 s97, s97, 114688
  s_cmp_eq_u32 s97, s95
  s_cselect_b32 s100, 1835008, 0
  s_sub_u32 s97, s97, s100
  s_waitcnt vmcnt(12)
  ds_read_b64_tr_b16 a[64:65], v5 offset:16384
  ds_read_b64_tr_b16 a[66:67], v5 offset:16896
  ds_read_b64_tr_b16 a[68:69], v6 offset:16384
  ds_read_b64_tr_b16 a[70:71], v6 offset:16896
  ds_read_b64_tr_b16 a[72:73], v7 offset:16384
  ds_read_b64_tr_b16 a[74:75], v7 offset:16896
  ds_read_b64_tr_b16 a[76:77], v8 offset:16384
  ds_read_b64_tr_b16 a[78:79], v8 offset:16896
  s_add_u32 m0, s96, 8192
  s_nop 0
  buffer_load_dwordx4 v172, s[56:59], s97 offen offset:0 lds
  buffer_load_dwordx4 v173, s[56:59], s97 offen offset:1024 lds
  buffer_load_dwordx4 v174, s[56:59], s97 offen offset:2048 lds
  buffer_load_dwordx4 v175, s[56:59], s97 offen offset:3072 lds
  s_add_u32 s97, s97, 114688
  s_waitcnt vmcnt(12)
  ds_read_b64_tr_b16 a[80:81], v5 offset:20480
  ds_read_b64_tr_b16 a[82:83], v5 offset:20992
  ds_read_b64_tr_b16 a[84:85], v6 offset:20480
  ds_read_b64_tr_b16 a[86:87], v6 offset:20992
  ds_read_b64_tr_b16 a[88:89], v7 offset:20480
  ds_read_b64_tr_b16 a[90:91], v7 offset:20992
  ds_read_b64_tr_b16 a[92:93], v8 offset:20480
  ds_read_b64_tr_b16 a[94:95], v8 offset:20992
  s_waitcnt lgkmcnt(0)
  s_add_u32 m0, s96, 12288
  s_nop 0
  buffer_load_dwordx4 v172, s[56:59], s97 offen offset:0 lds
  buffer_load_dwordx4 v173, s[56:59], s97 offen offset:1024 lds
  buffer_load_dwordx4 v174, s[56:59], s97 offen offset:2048 lds
  buffer_load_dwordx4 v175, s[56:59], s97 offen offset:3072 lds
  s_add_u32 s97, s97, 114688
  s_cmp_eq_u32 s97, s95
  s_cselect_b32 s100, 1835008, 0
  s_sub_u32 s97, s97, s100
  s_waitcnt vmcnt(12)
  ds_read_b64_tr_b16 a[96:97], v5 offset:0
  ds_read_b64_tr_b16 a[98:99], v5 offset:512
  ds_read_b64_tr_b16 a[100:101], v6 offset:0
  ds_read_b64_tr_b16 a[102:103], v6 offset:512
  ds_read_b64_tr_b16 a[104:105], v7 offset:0
  ds_read_b64_tr_b16 a[106:107], v7 offset:512
  ds_read_b64_tr_b16 a[108:109], v8 offset:0
  ds_read_b64_tr_b16 a[110:111], v8 offset:512
  s_add_u32 m0, s96, 16384
  s_nop 0
  buffer_load_dwordx4 v172, s[56:59], s97 offen offset:0 lds
  buffer_load_dwordx4 v173, s[56:59], s97 offen offset:1024 lds
  buffer_load_dwordx4 v174, s[56:59], s97 offen offset:2048 lds
  buffer_load_dwordx4 v175, s[56:59], s97 offen offset:3072 lds
  s_add_u32 s97, s97, 114688
  s_waitcnt vmcnt(12)
  ds_read_b64_tr_b16 a[112:113], v5 offset:4096
  ds_read_b64_tr_b16 a[114:115], v5 offset:4608
  ds_read_b64_tr_b16 a[116:117], v6 offset:4096
  ds_read_b64_tr_b16 a[118:119], v6 offset:4608
  ds_read_b64_tr_b16 a[120:121], v7 offset:4096
  ds_read_b64_tr_b16 a[122:123], v7 offset:4608
  ds_read_b64_tr_b16 a[124:125], v8 offset:4096
  ds_read_b64_tr_b16 a[126:127], v8 offset:4608
  s_add_u32 m0, s96, 20480
  s_nop 0
  buffer_load_dwordx4 v172, s[56:59], s97 offen offset:0 lds
  buffer_load_dwordx4 v173, s[56:59], s97 offen offset:1024 lds
  buffer_load_dwordx4 v174, s[56:59], s97 offen offset:2048 lds
  buffer_load_dwordx4 v175, s[56:59], s97 offen offset:3072 lds
  s_add_u32 s97, s97, 114688
  s_cmp_eq_u32 s97, s95
  s_cselect_b32 s100, 1835008, 0
  s_sub_u32 s97, s97, s100
  s_waitcnt vmcnt(12)
  ds_read_b64_tr_b16 a[128:129], v5 offset:8192
  ds_read_b64_tr_b16 a[130:131], v5 offset:8704
  ds_read_b64_tr_b16 a[132:133], v6 offset:8192
  ds_read_b64_tr_b16 a[134:135], v6 offset:8704
  ds_read_b64_tr_b16 a[136:137], v7 offset:8192
  ds_read_b64_tr_b16 a[138:139], v7 offset:8704
  ds_read_b64_tr_b16 a[140:141], v8 offset:8192
  ds_read_b64_tr_b16 a[142:143], v8 offset:8704
  s_waitcnt lgkmcnt(0)
  s_add_u32 m0, s96, 0
  s_nop 0
  buffer_load_dwordx4 v172, s[56:59], s97 offen offset:0 lds
  buffer_load_dwordx4 v173, s[56:59], s97 offen offset:1024 lds
  buffer_load_dwordx4 v174, s[56:59], s97 offen offset:2048 lds
  buffer_load_dwordx4 v175, s[56:59], s97 offen offset:3072 lds
  s_add_u32 s97, s97, 114688
  s_waitcnt vmcnt(12)
  ds_read_b64_tr_b16 a[144:145], v5 offset:12288
  ds_read_b64_tr_b16 a[146:147], v5 offset:12800
  ds_read_b64_tr_b16 a[148:149], v6 offset:12288
  ds_read_b64_tr_b16 a[150:151], v6 offset:12800
  ds_read_b64_tr_b16 a[152:153], v7 offset:12288
  ds_read_b64_tr_b16 a[154:155], v7 offset:12800
  ds_read_b64_tr_b16 a[156:157], v8 offset:12288
  ds_read_b64_tr_b16 a[158:159], v8 offset:12800
  s_add_u32 m0, s96, 4096
  s_nop 0
  buffer_load_dwordx4 v172, s[56:59], s97 offen offset:0 lds
  buffer_load_dwordx4 v173, s[56:59], s97 offen offset:1024 lds
  buffer_load_dwordx4 v174, s[56:59], s97 offen offset:2048 lds
  buffer_load_dwordx4 v175, s[56:59], s97 offen offset:3072 lds
  s_add_u32 s97, s97, 114688
  s_cmp_eq_u32 s97, s95
  s_cselect_b32 s100, 1835008, 0
  s_sub_u32 s97, s97, s100
  s_lshl_b32 s8, s80, 6
  s_mul_i32 s10, s8, 16
  s_add_u32 s10, s10, 8454144
  v_min_u32 v30, 63, v1
  v_mul_u32_u24 v30, 16, v30
  buffer_load_dword v31, v30, s[76:79], s10 offen sc1
  s_waitcnt vmcnt(13)
  ds_read_b64_tr_b16 a[160:161], v5 offset:16384
  ds_read_b64_tr_b16 a[162:163], v5 offset:16896
  ds_read_b64_tr_b16 a[164:165], v6 offset:16384
  ds_read_b64_tr_b16 a[166:167], v6 offset:16896
  ds_read_b64_tr_b16 a[168:169], v7 offset:16384
  ds_read_b64_tr_b16 a[170:171], v7 offset:16896
  ds_read_b64_tr_b16 a[172:173], v8 offset:16384
  ds_read_b64_tr_b16 a[174:175], v8 offset:16896
  s_add_u32 m0, s96, 8192
  s_nop 0
  buffer_load_dwordx4 v172, s[56:59], s97 offen offset:0 lds
  buffer_load_dwordx4 v173, s[56:59], s97 offen offset:1024 lds
  buffer_load_dwordx4 v174, s[56:59], s97 offen offset:2048 lds
  buffer_load_dwordx4 v175, s[56:59], s97 offen offset:3072 lds
  s_add_u32 s97, s97, 114688
  s_waitcnt vmcnt(13)
  ds_read_b64_tr_b16 a[176:177], v5 offset:20480
  ds_read_b64_tr_b16 a[178:179], v5 offset:20992
  ds_read_b64_tr_b16 a[180:181], v6 offset:20480
  ds_read_b64_tr_b16 a[182:183], v6 offset:20992
  ds_read_b64_tr_b16 a[184:185], v7 offset:20480
  ds_read_b64_tr_b16 a[186:187], v7 offset:20992
  ds_read_b64_tr_b16 a[188:189], v8 offset:20480
  ds_read_b64_tr_b16 a[190:191], v8 offset:20992
  s_waitcnt lgkmcnt(0)
  s_add_u32 m0, s96, 12288
  s_nop 0
  buffer_load_dwordx4 v172, s[56:59], s97 offen offset:0 lds
  buffer_load_dwordx4 v173, s[56:59], s97 offen offset:1024 lds
  buffer_load_dwordx4 v174, s[56:59], s97 offen offset:2048 lds
  buffer_load_dwordx4 v175, s[56:59], s97 offen offset:3072 lds
  s_add_u32 s97, s97, 114688
  s_cmp_eq_u32 s97, s95
  s_cselect_b32 s100, 1835008, 0
  s_sub_u32 s97, s97, s100
  s_waitcnt vmcnt(8)
  s_mov_b32 s9, 0
P4:
  v_cmp_ne_u32 vcc, s85, v31
  s_nop 4
  s_cbranch_vccz Q5
  s_sleep 4
  buffer_load_dword v31, v30, s[76:79], s10 offen sc1
  s_add_u32 s9, s9, 1
  s_cmp_lt_u32 s9, 0x40000
  s_waitcnt vmcnt(0)
  s_cbranch_scc1 P4
Q5:
  buffer_load_dwordx4 v[96:99], v2, s[76:79], s16 offen offset:0 sc1
  buffer_load_dwordx4 v[100:103], v2, s[76:79], s16 offen offset:1024 sc1
  buffer_load_dwordx4 v[104:107], v2, s[76:79], s16 offen offset:2048 sc1
  buffer_load_dwordx4 v[108:111], v2, s[76:79], s16 offen offset:3072 sc1
  s_add_u32 s16, s16, 4096
  buffer_load_dwordx4 v[112:115], v2, s[76:79], s16 offen offset:0 sc1
  buffer_load_dwordx4 v[116:119], v2, s[76:79], s16 offen offset:1024 sc1
  buffer_load_dwordx4 v[120:123], v2, s[76:79], s16 offen offset:2048 sc1
  buffer_load_dwordx4 v[124:127], v2, s[76:79], s16 offen offset:3072 sc1
  s_add_u32 s16, s16, 4096
  s_cmp_eq_u32 s16, s3
  s_cselect_b32 s100, 65536, 0
  s_sub_u32 s16, s16, s100
  buffer_load_dwordx4 v[128:131], v2, s[76:79], s16 offen offset:0 sc1
  buffer_load_dwordx4 v[132:135], v2, s[76:79], s16 offen offset:1024 sc1
  buffer_load_dwordx4 v[136:139], v2, s[76:79], s16 offen offset:2048 sc1
  buffer_load_dwordx4 v[140:143], v2, s[76:79], s16 offen offset:3072 sc1
  s_add_u32 s16, s16, 4096
  buffer_load_dwordx4 v[144:147], v2, s[76:79], s16 offen offset:0 sc1
  buffer_load_dwordx4 v[148:151], v2, s[76:79], s16 offen offset:1024 sc1
  buffer_load_dwordx4 v[152:155], v2, s[76:79], s16 offen offset:2048 sc1
  buffer_load_dwordx4 v[156:159], v2, s[76:79], s16 offen offset:3072 sc1
  s_add_u32 s16, s16, 4096
  s_cmp_eq_u32 s16, s3
  s_cselect_b32 s100, 65536, 0
  s_sub_u32 s16, s16, s100
  ds_read_b64_tr_b16 a[192:193], v5 offset:0
  ds_read_b64_tr_b16 a[194:195], v5 offset:512
  ds_read_b64_tr_b16 a[196:197], v6 offset:0
  ds_read_b64_tr_b16 a[198:199], v6 offset:512
  ds_read_b64_tr_b16 a[200:201], v7 offset:0
  ds_read_b64_tr_b16 a[202:203], v7 offset:512
  ds_read_b64_tr_b16 a[204:205], v8 offset:0
  ds_read_b64_tr_b16 a[206:207], v8 offset:512
  ds_read_b64_tr_b16 a[208:209], v5 offset:4096
  ds_read_b64_tr_b16 a[210:211], v5 offset:4608
  ds_read_b64_tr_b16 a[212:213], v6 offset:4096
  ds_read_b64_tr_b16 a[214:215], v6 offset:4608
  ds_read_b64_tr_b16 a[216:217], v7 offset:4096
  ds_read_b64_tr_b16 a[218:219], v7 offset:4608
  ds_read_b64_tr_b16 a[220:221], v8 offset:4096
  ds_read_b64_tr_b16 a[222:223], v8 offset:4608
  s_waitcnt vmcnt(12)
  s_waitcnt lgkmcnt(0)
  v_mfma_f32_16x16x32_bf16 v[32:35], a[0:3], v[96:99], 0
  ds_read_b64_tr_b16 a[224:225], v5 offset:8192
  ds_read_b64_tr_b16 a[226:227], v5 offset:8704
  v_mfma_f32_16x16x32_bf16 v[48:51], a[4:7], v[96:99], 0
  ds_read_b64_tr_b16 a[228:229], v6 offset:8192
  ds_read_b64_tr_b16 a[230:231], v6 offset:8704
  v_mfma_f32_16x16x32_bf16 v[64:67], a[8:11], v[96:99], 0
  ds_read_b64_tr_b16 a[232:233], v7 offset:8192
  ds_read_b64_tr_b16 a[234:235], v7 offset:8704
  v_mfma_f32_16x16x32_bf16 v[80:83], a[12:15], v[96:99], 0
  buffer_load_dwordx4 v[96:99], v2, s[76:79], s16 offen offset:0 sc1
  ds_read_b64_tr_b16 a[236:237], v8 offset:8192
  v_mfma_f32_16x16x32_bf16 v[36:39], a[0:3], v[100:103], 0
  ds_read_b64_tr_b16 a[238:239], v8 offset:8704
  ds_read_b64_tr_b16 a[240:241], v5 offset:12288
  v_mfma_f32_16x16x32_bf16 v[52:55], a[4:7], v[100:103], 0
  ds_read_b64_tr_b16 a[242:243], v5 offset:12800
  ds_read_b64_tr_b16 a[244:245], v6 offset:12288
  v_mfma_f32_16x16x32_bf16 v[68:71], a[8:11], v[100:103], 0
  ds_read_b64_tr_b16 a[246:247], v6 offset:12800
  ds_read_b64_tr_b16 a[248:249], v7 offset:12288
  v_mfma_f32_16x16x32_bf16 v[84:87], a[12:15], v[100:103], 0
  buffer_load_dwordx4 v[100:103], v2, s[76:79], s16 offen offset:1024 sc1
  ds_read_b64_tr_b16 a[250:251], v7 offset:12800
  v_mfma_f32_16x16x32_bf16 v[40:43], a[0:3], v[104:107], 0
  ds_read_b64_tr_b16 a[252:253], v8 offset:12288
  ds_read_b64_tr_b16 a[254:255], v8 offset:12800
  v_mfma_f32_16x16x32_bf16 v[56:59], a[4:7], v[104:107], 0
  v_mfma_f32_16x16x32_bf16 v[72:75], a[8:11], v[104:107], 0
  v_mfma_f32_16x16x32_bf16 v[88:91], a[12:15], v[104:107], 0
  buffer_load_dwordx4 v[104:107], v2, s[76:79], s16 offen offset:2048 sc1
  v_mfma_f32_16x16x32_bf16 v[44:47], a[0:3], v[108:111], 0
  v_mfma_f32_16x16x32_bf16 v[60:63], a[4:7], v[108:111], 0
  v_mfma_f32_16x16x32_bf16 v[76:79], a[8:11], v[108:111], 0
  v_mfma_f32_16x16x32_bf16 v[92:95], a[12:15], v[108:111], 0
  buffer_load_dwordx4 v[108:111], v2, s[76:79], s16 offen offset:3072 sc1
  s_add_u32 s16, s16, 4096
  s_waitcnt vmcnt(12)
  s_waitcnt lgkmcnt(0)
  v_mfma_f32_16x16x32_bf16 v[32:35], a[16:19], v[112:115], v[32:35]
  s_lshl_b32 s15, s83, 5
  s_add_u32 s15, s15, s84
  v_mfma_f32_16x16x32_bf16 v[48:51], a[20:23], v[112:115], v[48:51]
  s_lshl_b32 s13, s15, 2
  s_lshl_b32 s15, s15, 13
  v_mfma_f32_16x16x32_bf16 v[64:67], a[24:27], v[112:115], v[64:67]
  s_lshl_b32 s14, s80, 11
  s_add_u32 s14, s14, s15
  v_mfma_f32_16x16x32_bf16 v[80:83], a[28:31], v[112:115], v[80:83]
  buffer_load_dwordx4 v[112:115], v2, s[76:79], s16 offen offset:0 sc1
  s_lshr_b32 s9, s80, 1
  v_mfma_f32_16x16x32_bf16 v[36:39], a[16:19], v[116:119], v[36:39]
  s_mul_i32 s12, s9, 12544
  s_lshl_b32 s9, s9, 1
  v_mfma_f32_16x16x32_bf16 v[52:55], a[20:23], v[116:119], v[52:55]
  s_add_u32 s13, s13, s9
  s_lshl_b32 s9, s80, 11
  v_mfma_f32_16x16x32_bf16 v[68:71], a[24:27], v[116:119], v[68:71]
  s_add_u32 s12, s12, s9
  s_add_u32 s12, s12, 32
  v_mfma_f32_16x16x32_bf16 v[84:87], a[28:31], v[116:119], v[84:87]
  buffer_load_dwordx4 v[116:119], v2, s[76:79], s16 offen offset:1024 sc1
  v_add_u32 v3, s12, v2
  v_mfma_f32_16x16x32_bf16 v[40:43], a[16:19], v[120:123], v[40:43]
  v_bfe_u32 v19, v1, 2, 1
  v_lshlrev_b32 v19, 12, v19
  v_mfma_f32_16x16x32_bf16 v[56:59], a[20:23], v[120:123], v[56:59]
  v_mov_b32 v22, 0
  buffer_load_dwordx4 v[176:179], v2, s[48:51], s14 offen offset:0
  v_mfma_f32_16x16x32_bf16 v[72:75], a[24:27], v[120:123], v[72:75]
  v_mfma_f32_16x16x32_bf16 v[88:91], a[28:31], v[120:123], v[88:91]
  buffer_load_dwordx4 v[120:123], v2, s[76:79], s16 offen offset:2048 sc1
  v_mfma_f32_16x16x32_bf16 v[44:47], a[16:19], v[124:127], v[44:47]
  v_mfma_f32_16x16x32_bf16 v[60:63], a[20:23], v[124:127], v[60:63]
  buffer_load_dwordx2 v[180:181], v2, s[48:51], s14 offen offset:16
  v_mfma_f32_16x16x32_bf16 v[76:79], a[24:27], v[124:127], v[76:79]
  v_mfma_f32_16x16x32_bf16 v[92:95], a[28:31], v[124:127], v[92:95]
  buffer_load_dwordx4 v[124:127], v2, s[76:79], s16 offen offset:3072 sc1
  s_add_u32 s16, s16, 4096
  s_cmp_eq_u32 s16, s3
  s_cselect_b32 s100, 65536, 0
  s_sub_u32 s16, s16, s100
  s_waitcnt vmcnt(14)
  v_mfma_f32_16x16x32_bf16 v[32:35], a[32:35], v[128:131], v[32:35]
  v_mfma_f32_16x16x32_bf16 v[48:51], a[36:39], v[128:131], v[48:51]
  buffer_load_dwordx4 v[182:185], v2, s[48:51], s14 offen offset:1024
  v_mfma_f32_16x16x32_bf16 v[64:67], a[40:43], v[128:131], v[64:67]
  v_mfma_f32_16x16x32_bf16 v[80:83], a[44:47], v[128:131], v[80:83]
  buffer_load_dwordx4 v[128:131], v2, s[76:79], s16 offen offset:0 sc1
  v_mfma_f32_16x16x32_bf16 v[36:39], a[32:35], v[132:135], v[36:39]
  v_mfma_f32_16x16x32_bf16 v[52:55], a[36:39], v[132:135], v[52:55]
  buffer_load_dwordx2 v[186:187], v2, s[48:51], s14 offen offset:1040
  v_mfma_f32_16x16x32_bf16 v[68:71], a[40:43], v[132:135], v[68:71]
  v_mfma_f32_16x16x32_bf16 v[84:87], a[44:47], v[132:135], v[84:87]
  buffer_load_dwordx4 v[132:135], v2, s[76:79], s16 offen offset:1024 sc1
  v_mfma_f32_16x16x32_bf16 v[40:43], a[32:35], v[136:139], v[40:43]
  v_mfma_f32_16x16x32_bf16 v[56:59], a[36:39], v[136:139], v[56:59]
  buffer_load_dwordx2 v[20:21], v19, s[48:51], s15 offen
  v_mfma_f32_16x16x32_bf16 v[72:75], a[40:43], v[136:139], v[72:75]
  v_mfma_f32_16x16x32_bf16 v[88:91], a[44:47], v[136:139], v[88:91]
  buffer_load_dwordx4 v[136:139], v2, s[76:79], s16 offen offset:2048 sc1
  v_mfma_f32_16x16x32_bf16 v[44:47], a[32:35], v[140:143], v[44:47]
  v_mfma_f32_16x16x32_bf16 v[60:63], a[36:39], v[140:143], v[60:63]
  buffer_load_ushort v11, v22, s[52:55], s13 offen
  v_lshlrev_b32 v160, 16, v28
  v_mfma_f32_16x16x32_bf16 v[76:79], a[40:43], v[140:143], v[76:79]
  v_and_b32 v161, 0xffff0000, v28
  v_lshlrev_b32 v162, 16, v29
  v_mfma_f32_16x16x32_bf16 v[92:95], a[44:47], v[140:143], v[92:95]
  buffer_load_dwordx4 v[140:143], v2, s[76:79], s16 offen offset:3072 sc1
  s_add_u32 s16, s16, 4096
  s_waitcnt vmcnt(18)
  v_mfma_f32_16x16x32_bf16 v[32:35], a[48:51], v[144:147], v[32:35]
  v_and_b32 v163, 0xffff0000, v29
  v_mov_b32 v164, 0xc0135761
  v_mfma_f32_16x16x32_bf16 v[48:51], a[52:55], v[144:147], v[48:51]
  v_mov_b32 v165, 0xbdd2d3e8
  v_lshrrev_b32 v16, 3, v1
  v_mfma_f32_16x16x32_bf16 v[64:67], a[56:59], v[144:147], v[64:67]
  v_and_b32 v17, 7, v1
  v_bfe_u32 v18, v1, 4, 1
  v_mfma_f32_16x16x32_bf16 v[80:83], a[60:63], v[144:147], v[80:83]
  buffer_load_dwordx4 v[144:147], v2, s[76:79], s16 offen offset:0 sc1
  v_lshlrev_b32 v18, 1, v18
  v_mfma_f32_16x16x32_bf16 v[36:39], a[48:51], v[148:151], v[36:39]
  v_xor_b32 v17, v17, v18
  v_lshlrev_b32 v17, 4, v17
  v_mfma_f32_16x16x32_bf16 v[52:55], a[52:55], v[148:151], v[52:55]
  v_mul_u32_u24 v16, 4096, v16
  v_add_u32 v172, v16, v17
  v_mfma_f32_16x16x32_bf16 v[68:71], a[56:59], v[148:151], v[68:71]
  v_xor_b32 v17, 64, v17
  v_add_u32 v16, v16, v17
  v_mfma_f32_16x16x32_bf16 v[84:87], a[60:63], v[148:151], v[84:87]
  buffer_load_dwordx4 v[148:151], v2, s[76:79], s16 offen offset:1024 sc1
  v_add_u32 v173, 31744, v16
  v_mfma_f32_16x16x32_bf16 v[40:43], a[48:51], v[152:155], v[40:43]
  v_add_u32 v174, 63488, v172
  v_add_u32 v175, 95232, v16
  v_mfma_f32_16x16x32_bf16 v[56:59], a[52:55], v[152:155], v[56:59]
  s_mul_i32 s97, s80, 1835008
  s_lshl_b32 s96, s84, 7
  v_mfma_f32_16x16x32_bf16 v[72:75], a[56:59], v[152:155], v[72:75]
  s_add_u32 s97, s97, s96
  s_add_u32 s95, s97, 1835008
  v_mfma_f32_16x16x32_bf16 v[88:91], a[60:63], v[152:155], v[88:91]
  buffer_load_dwordx4 v[152:155], v2, s[76:79], s16 offen offset:2048 sc1
  s_mul_i32 s96, s83, 262144
  v_mfma_f32_16x16x32_bf16 v[44:47], a[48:51], v[156:159], v[44:47]
  s_add_u32 s97, s97, s96
  s_mul_i32 s96, s80, 24576
  v_mfma_f32_16x16x32_bf16 v[60:63], a[52:55], v[156:159], v[60:63]
  s_add_u32 s96, s96, 51712
  v_and_b32 v16, 15, v1
  v_mfma_f32_16x16x32_bf16 v[76:79], a[56:59], v[156:159], v[76:79]
  v_lshrrev_b32 v17, 4, v1
  v_add_u32 v18, 1, v16
  v_mfma_f32_16x16x32_bf16 v[92:95], a[60:63], v[156:159], v[92:95]
  buffer_load_dwordx4 v[156:159], v2, s[76:79], s16 offen offset:3072 sc1
  s_add_u32 s16, s16, 4096
  s_cmp_eq_u32 s16, s3
  s_cselect_b32 s100, 65536, 0
  s_sub_u32 s16, s16, s100
  s_waitcnt vmcnt(18)
  v_mfma_f32_16x16x32_bf16 v[32:35], a[64:67], v[96:99], v[32:35]
  v_and_b32 v166, 3, v18
  v_mul_u32_u24 v166, 4160, v166
  v_mfma_f32_16x16x32_bf16 v[48:51], a[68:71], v[96:99], v[48:51]
  v_and_b32 v18, 28, v18
  v_lshl_add_u32 v18, v17, 3, v18
  v_mfma_f32_16x16x32_bf16 v[64:67], a[72:75], v[96:99], v[64:67]
  v_lshl_add_u32 v166, v18, 1, v166
  s_lshr_b32 s14, s80, 1
  v_mfma_f32_16x16x32_bf16 v[80:83], a[76:79], v[96:99], v[80:83]
  buffer_load_dwordx4 v[96:99], v2, s[76:79], s16 offen offset:0 sc1
  s_and_b32 s15, s80, 1
  v_mfma_f32_16x16x32_bf16 v[36:39], a[64:67], v[100:103], v[36:39]
  s_mul_i32 s12, s14, 16640
  s_lshl_b32 s11, s15, 8
  v_mfma_f32_16x16x32_bf16 v[52:55], a[68:71], v[100:103], v[52:55]
  s_add_u32 s12, s12, s11
  s_add_u32 s12, s12, 0
  v_mfma_f32_16x16x32_bf16 v[68:71], a[72:75], v[100:103], v[68:71]
  v_add_u32 v166, s12, v166
  v_lshlrev_b32 v18, 1, v16
  v_mfma_f32_16x16x32_bf16 v[84:87], a[76:79], v[100:103], v[84:87]
  buffer_load_dwordx4 v[100:103], v2, s[76:79], s16 offen offset:1024 sc1
  v_sub_u32 v18, v17, v18
  v_mfma_f32_16x16x32_bf16 v[40:43], a[64:67], v[104:107], v[40:43]
  v_add_u32 v18, 30, v18
  v_lshlrev_b32 v167, 4, v18
  v_mfma_f32_16x16x32_bf16 v[56:59], a[68:71], v[104:107], v[56:59]
  s_mul_i32 s13, s14, 4608
  s_add_u32 s12, s13, s11
  v_mfma_f32_16x16x32_bf16 v[72:75], a[72:75], v[104:107], v[72:75]
  s_add_u32 s12, s12, 33280
  v_add_u32 v167, s12, v167
  v_mfma_f32_16x16x32_bf16 v[88:91], a[76:79], v[104:107], v[88:91]
  buffer_load_dwordx4 v[104:107], v2, s[76:79], s16 offen offset:2048 sc1
  v_lshlrev_b32 v18, 2, v16
  v_mfma_f32_16x16x32_bf16 v[44:47], a[64:67], v[108:111], v[44:47]
  v_add_u32 v18, v18, v17
  v_lshlrev_b32 v18, 3, v18
  v_mfma_f32_16x16x32_bf16 v[60:63], a[68:71], v[108:111], v[60:63]
  s_lshl_b32 s11, s15, 11
  s_sub_u32 s13, s13, s11
  v_mfma_f32_16x16x32_bf16 v[76:79], a[72:75], v[108:111], v[76:79]
  s_add_u32 s13, s13, 35832
  v_sub_u32 v168, s13, v18
  v_mfma_f32_16x16x32_bf16 v[92:95], a[76:79], v[108:111], v[92:95]
  buffer_load_dwordx4 v[108:111], v2, s[76:79], s16 offen offset:3072 sc1
  s_add_u32 s16, s16, 4096
  s_waitcnt vmcnt(16)
  v_mfma_f32_16x16x32_bf16 v[32:35], a[80:83], v[112:115], v[32:35]
  v_mfma_f32_16x16x32_bf16 v[48:51], a[84:87], v[112:115], v[48:51]
  v_mfma_f32_16x16x32_bf16 v[64:67], a[88:91], v[112:115], v[64:67]
  v_mfma_f32_16x16x32_bf16 v[80:83], a[92:95], v[112:115], v[80:83]
  buffer_load_dwordx4 v[112:115], v2, s[76:79], s16 offen offset:0 sc1
  v_mfma_f32_16x16x32_bf16 v[36:39], a[80:83], v[116:119], v[36:39]
  v_mfma_f32_16x16x32_bf16 v[52:55], a[84:87], v[116:119], v[52:55]
  v_mfma_f32_16x16x32_bf16 v[68:71], a[88:91], v[116:119], v[68:71]
  v_mfma_f32_16x16x32_bf16 v[84:87], a[92:95], v[116:119], v[84:87]
  buffer_load_dwordx4 v[116:119], v2, s[76:79], s16 offen offset:1024 sc1
  v_mfma_f32_16x16x32_bf16 v[40:43], a[80:83], v[120:123], v[40:43]
  v_mfma_f32_16x16x32_bf16 v[56:59], a[84:87], v[120:123], v[56:59]
  v_mfma_f32_16x16x32_bf16 v[72:75], a[88:91], v[120:123], v[72:75]
  v_mfma_f32_16x16x32_bf16 v[88:91], a[92:95], v[120:123], v[88:91]
  buffer_load_dwordx4 v[120:123], v2, s[76:79], s16 offen offset:2048 sc1
  v_mfma_f32_16x16x32_bf16 v[44:47], a[80:83], v[124:127], v[44:47]
  v_mfma_f32_16x16x32_bf16 v[60:63], a[84:87], v[124:127], v[60:63]
  v_mfma_f32_16x16x32_bf16 v[76:79], a[88:91], v[124:127], v[76:79]
  v_mfma_f32_16x16x32_bf16 v[92:95], a[92:95], v[124:127], v[92:95]
  buffer_load_dwordx4 v[124:127], v2, s[76:79], s16 offen offset:3072 sc1
  s_add_u32 s16, s16, 4096
  s_cmp_eq_u32 s16, s3
  s_cselect_b32 s100, 65536, 0
  s_sub_u32 s16, s16, s100
  s_waitcnt vmcnt(12)
  v_mfma_f32_16x16x32_bf16 v[32:35], a[96:99], v[128:131], v[32:35]
  v_mfma_f32_16x16x32_bf16 v[48:51], a[100:103], v[128:131], v[48:51]
  v_mfma_f32_16x16x32_bf16 v[64:67], a[104:107], v[128:131], v[64:67]
  v_mfma_f32_16x16x32_bf16 v[80:83], a[108:111], v[128:131], v[80:83]
  buffer_load_dwordx4 v[128:131], v2, s[76:79], s16 offen offset:0 sc1
  v_mfma_f32_16x16x32_bf16 v[36:39], a[96:99], v[132:135], v[36:39]
  v_mfma_f32_16x16x32_bf16 v[52:55], a[100:103], v[132:135], v[52:55]
  v_mfma_f32_16x16x32_bf16 v[68:71], a[104:107], v[132:135], v[68:71]
  v_mfma_f32_16x16x32_bf16 v[84:87], a[108:111], v[132:135], v[84:87]
  buffer_load_dwordx4 v[132:135], v2, s[76:79], s16 offen offset:1024 sc1
  v_mfma_f32_16x16x32_bf16 v[40:43], a[96:99], v[136:139], v[40:43]
  v_mfma_f32_16x16x32_bf16 v[56:59], a[100:103], v[136:139], v[56:59]
  v_mfma_f32_16x16x32_bf16 v[72:75], a[104:107], v[136:139], v[72:75]
  v_mfma_f32_16x16x32_bf16 v[88:91], a[108:111], v[136:139], v[88:91]
  buffer_load_dwordx4 v[136:139], v2, s[76:79], s16 offen offset:2048 sc1
  v_mfma_f32_16x16x32_bf16 v[44:47], a[96:99], v[140:143], v[44:47]
  v_mfma_f32_16x16x32_bf16 v[60:63], a[100:103], v[140:143], v[60:63]
  v_mfma_f32_16x16x32_bf16 v[76:79], a[104:107], v[140:143], v[76:79]
  v_mfma_f32_16x16x32_bf16 v[92:95], a[108:111], v[140:143], v[92:95]
  buffer_load_dwordx4 v[140:143], v2, s[76:79], s16 offen offset:3072 sc1
  s_add_u32 s16, s16, 4096
  s_waitcnt vmcnt(12)
  v_mfma_f32_16x16x32_bf16 v[32:35], a[112:115], v[144:147], v[32:35]
  v_mfma_f32_16x16x32_bf16 v[48:51], a[116:119], v[144:147], v[48:51]
  v_mfma_f32_16x16x32_bf16 v[64:67], a[120:123], v[144:147], v[64:67]
  v_mfma_f32_16x16x32_bf16 v[80:83], a[124:127], v[144:147], v[80:83]
  buffer_load_dwordx4 v[144:147], v2, s[76:79], s16 offen offset:0 sc1
  v_mfma_f32_16x16x32_bf16 v[36:39], a[112:115], v[148:151], v[36:39]
  v_mfma_f32_16x16x32_bf16 v[52:55], a[116:119], v[148:151], v[52:55]
  v_mfma_f32_16x16x32_bf16 v[68:71], a[120:123], v[148:151], v[68:71]
  v_mfma_f32_16x16x32_bf16 v[84:87], a[124:127], v[148:151], v[84:87]
  buffer_load_dwordx4 v[148:151], v2, s[76:79], s16 offen offset:1024 sc1
  v_mfma_f32_16x16x32_bf16 v[40:43], a[112:115], v[152:155], v[40:43]
  v_mfma_f32_16x16x32_bf16 v[56:59], a[116:119], v[152:155], v[56:59]
  v_mfma_f32_16x16x32_bf16 v[72:75], a[120:123], v[152:155], v[72:75]
  v_mfma_f32_16x16x32_bf16 v[88:91], a[124:127], v[152:155], v[88:91]
  buffer_load_dwordx4 v[152:155], v2, s[76:79], s16 offen offset:2048 sc1
  v_mfma_f32_16x16x32_bf16 v[44:47], a[112:115], v[156:159], v[44:47]
  v_mfma_f32_16x16x32_bf16 v[60:63], a[116:119], v[156:159], v[60:63]
  v_mfma_f32_16x16x32_bf16 v[76:79], a[120:123], v[156:159], v[76:79]
  v_mfma_f32_16x16x32_bf16 v[92:95], a[124:127], v[156:159], v[92:95]
  buffer_load_dwordx4 v[156:159], v2, s[76:79], s16 offen offset:3072 sc1
  s_add_u32 s16, s16, 4096
  s_cmp_eq_u32 s16, s3
  s_cselect_b32 s100, 65536, 0
  s_sub_u32 s16, s16, s100
  s_waitcnt vmcnt(12)
  v_mfma_f32_16x16x32_bf16 v[32:35], a[128:131], v[96:99], v[32:35]
  v_mfma_f32_16x16x32_bf16 v[48:51], a[132:135], v[96:99], v[48:51]
  v_mfma_f32_16x16x32_bf16 v[64:67], a[136:139], v[96:99], v[64:67]
  v_mfma_f32_16x16x32_bf16 v[80:83], a[140:143], v[96:99], v[80:83]
  buffer_load_dwordx4 v[96:99], v2, s[76:79], s16 offen offset:0 sc1
  v_mfma_f32_16x16x32_bf16 v[36:39], a[128:131], v[100:103], v[36:39]
  v_mfma_f32_16x16x32_bf16 v[52:55], a[132:135], v[100:103], v[52:55]
  v_mfma_f32_16x16x32_bf16 v[68:71], a[136:139], v[100:103], v[68:71]
  v_mfma_f32_16x16x32_bf16 v[84:87], a[140:143], v[100:103], v[84:87]
  buffer_load_dwordx4 v[100:103], v2, s[76:79], s16 offen offset:1024 sc1
  v_mfma_f32_16x16x32_bf16 v[40:43], a[128:131], v[104:107], v[40:43]
  v_mfma_f32_16x16x32_bf16 v[56:59], a[132:135], v[104:107], v[56:59]
  v_mfma_f32_16x16x32_bf16 v[72:75], a[136:139], v[104:107], v[72:75]
  v_mfma_f32_16x16x32_bf16 v[88:91], a[140:143], v[104:107], v[88:91]
  buffer_load_dwordx4 v[104:107], v2, s[76:79], s16 offen offset:2048 sc1
  v_mfma_f32_16x16x32_bf16 v[44:47], a[128:131], v[108:111], v[44:47]
  v_mfma_f32_16x16x32_bf16 v[60:63], a[132:135], v[108:111], v[60:63]
  v_mfma_f32_16x16x32_bf16 v[76:79], a[136:139], v[108:111], v[76:79]
  v_mfma_f32_16x16x32_bf16 v[92:95], a[140:143], v[108:111], v[92:95]
  buffer_load_dwordx4 v[108:111], v2, s[76:79], s16 offen offset:3072 sc1
  s_add_u32 s16, s16, 4096
  s_waitcnt vmcnt(12)
  v_mfma_f32_16x16x32_bf16 v[32:35], a[144:147], v[112:115], v[32:35]
  ds_write_b128 v3, v[176:179] offset:0
  v_alignbit_b32 v188, v177, v176, 16
  v_mfma_f32_16x16x32_bf16 v[48:51], a[148:151], v[112:115], v[48:51]
  v_alignbit_b32 v189, v178, v177, 16
  v_alignbit_b32 v190, v179, v178, 16
  v_mfma_f32_16x16x32_bf16 v[64:67], a[152:155], v[112:115], v[64:67]
  v_alignbit_b32 v191, v180, v179, 16
  ds_write_b128 v3, v[188:191] offset:4160
  v_mfma_f32_16x16x32_bf16 v[80:83], a[156:159], v[112:115], v[80:83]
  buffer_load_dwordx4 v[112:115], v2, s[76:79], s16 offen offset:0 sc1
  v_mov_b32 v192, v177
  v_mfma_f32_16x16x32_bf16 v[36:39], a[144:147], v[116:119], v[36:39]
  v_mov_b32 v193, v178
  v_mov_b32 v194, v179
  v_mfma_f32_16x16x32_bf16 v[52:55], a[148:151], v[116:119], v[52:55]
  v_mov_b32 v195, v180
  ds_write_b128 v3, v[192:195] offset:8320
  v_mfma_f32_16x16x32_bf16 v[68:71], a[152:155], v[116:119], v[68:71]
  v_alignbit_b32 v179, v181, v180, 16
  v_mov_b32 v176, v189
  v_mfma_f32_16x16x32_bf16 v[84:87], a[156:159], v[116:119], v[84:87]
  buffer_load_dwordx4 v[116:119], v2, s[76:79], s16 offen offset:1024 sc1
  v_mov_b32 v177, v190
  v_mfma_f32_16x16x32_bf16 v[40:43], a[144:147], v[120:123], v[40:43]
  v_mov_b32 v178, v191
  ds_write_b128 v3, v[176:179] offset:12480
  v_mfma_f32_16x16x32_bf16 v[56:59], a[148:151], v[120:123], v[56:59]
  ds_write_b128 v3, v[182:185] offset:1024
  v_alignbit_b32 v196, v183, v182, 16
  v_mfma_f32_16x16x32_bf16 v[72:75], a[152:155], v[120:123], v[72:75]
  v_alignbit_b32 v197, v184, v183, 16
  v_alignbit_b32 v198, v185, v184, 16
  v_mfma_f32_16x16x32_bf16 v[88:91], a[156:159], v[120:123], v[88:91]
  buffer_load_dwordx4 v[120:123], v2, s[76:79], s16 offen offset:2048 sc1
  v_alignbit_b32 v199, v186, v185, 16
  v_mfma_f32_16x16x32_bf16 v[44:47], a[144:147], v[124:127], v[44:47]
  ds_write_b128 v3, v[196:199] offset:5184
  v_mov_b32 v200, v183
  v_mfma_f32_16x16x32_bf16 v[60:63], a[148:151], v[124:127], v[60:63]
  v_mov_b32 v201, v184
  v_mov_b32 v202, v185
  v_mfma_f32_16x16x32_bf16 v[76:79], a[152:155], v[124:127], v[76:79]
  v_mov_b32 v203, v186
  ds_write_b128 v3, v[200:203] offset:9344
  v_mfma_f32_16x16x32_bf16 v[92:95], a[156:159], v[124:127], v[92:95]
  buffer_load_dwordx4 v[124:127], v2, s[76:79], s16 offen offset:3072 sc1
  s_add_u32 s16, s16, 4096
  s_cmp_eq_u32 s16, s3
  s_cselect_b32 s100, 65536, 0
  s_sub_u32 s16, s16, s100
  s_waitcnt vmcnt(12)
  v_mfma_f32_16x16x32_bf16 v[32:35], a[160:163], v[128:131], v[32:35]
  v_alignbit_b32 v185, v187, v186, 16
  v_mov_b32 v182, v197
  v_mfma_f32_16x16x32_bf16 v[48:51], a[164:167], v[128:131], v[48:51]
  v_mov_b32 v183, v198
  v_mov_b32 v184, v199
  v_mfma_f32_16x16x32_bf16 v[64:67], a[168:171], v[128:131], v[64:67]
  ds_write_b128 v3, v[182:185] offset:13504
  v_mfma_f32_16x16x32_bf16 v[80:83], a[172:175], v[128:131], v[80:83]
  buffer_load_dwordx4 v[128:131], v2, s[76:79], s16 offen offset:0 sc1
  v_mfma_f32_16x16x32_bf16 v[36:39], a[160:163], v[132:135], v[36:39]
  v_mfma_f32_16x16x32_bf16 v[52:55], a[164:167], v[132:135], v[52:55]
  v_mfma_f32_16x16x32_bf16 v[68:71], a[168:171], v[132:135], v[68:71]
  v_mfma_f32_16x16x32_bf16 v[84:87], a[172:175], v[132:135], v[84:87]
  buffer_load_dwordx4 v[132:135], v2, s[76:79], s16 offen offset:1024 sc1
  v_mfma_f32_16x16x32_bf16 v[40:43], a[160:163], v[136:139], v[40:43]
  v_mfma_f32_16x16x32_bf16 v[56:59], a[164:167], v[136:139], v[56:59]
  v_mfma_f32_16x16x32_bf16 v[72:75], a[168:171], v[136:139], v[72:75]
  v_mfma_f32_16x16x32_bf16 v[88:91], a[172:175], v[136:139], v[88:91]
  buffer_load_dwordx4 v[136:139], v2, s[76:79], s16 offen offset:2048 sc1
  v_mfma_f32_16x16x32_bf16 v[44:47], a[160:163], v[140:143], v[44:47]
  v_mfma_f32_16x16x32_bf16 v[60:63], a[164:167], v[140:143], v[60:63]
  v_mfma_f32_16x16x32_bf16 v[76:79], a[168:171], v[140:143], v[76:79]
  v_mfma_f32_16x16x32_bf16 v[92:95], a[172:175], v[140:143], v[92:95]
  buffer_load_dwordx4 v[140:143], v2, s[76:79], s16 offen offset:3072 sc1
  s_add_u32 s16, s16, 4096
  s_waitcnt vmcnt(12)
  v_mfma_f32_16x16x32_bf16 v[32:35], a[176:179], v[144:147], v[32:35]
  v_mfma_f32_16x16x32_bf16 v[48:51], a[180:183], v[144:147], v[48:51]
  v_mfma_f32_16x16x32_bf16 v[64:67], a[184:187], v[144:147], v[64:67]
  v_mfma_f32_16x16x32_bf16 v[80:83], a[188:191], v[144:147], v[80:83]
  buffer_load_dwordx4 v[144:147], v2, s[76:79], s16 offen offset:0 sc1
  v_mfma_f32_16x16x32_bf16 v[36:39], a[176:179], v[148:151], v[36:39]
  v_mfma_f32_16x16x32_bf16 v[52:55], a[180:183], v[148:151], v[52:55]
  v_mfma_f32_16x16x32_bf16 v[68:71], a[184:187], v[148:151], v[68:71]
  v_mfma_f32_16x16x32_bf16 v[84:87], a[188:191], v[148:151], v[84:87]
  buffer_load_dwordx4 v[148:151], v2, s[76:79], s16 offen offset:1024 sc1
  v_mfma_f32_16x16x32_bf16 v[40:43], a[176:179], v[152:155], v[40:43]
  v_mfma_f32_16x16x32_bf16 v[56:59], a[180:183], v[152:155], v[56:59]
  v_mfma_f32_16x16x32_bf16 v[72:75], a[184:187], v[152:155], v[72:75]
  v_mfma_f32_16x16x32_bf16 v[88:91], a[188:191], v[152:155], v[88:91]
  buffer_load_dwordx4 v[152:155], v2, s[76:79], s16 offen offset:2048 sc1
  v_mfma_f32_16x16x32_bf16 v[44:47], a[176:179], v[156:159], v[44:47]
  v_mfma_f32_16x16x32_bf16 v[60:63], a[180:183], v[156:159], v[60:63]
  v_mfma_f32_16x16x32_bf16 v[76:79], a[184:187], v[156:159], v[76:79]
  v_mfma_f32_16x16x32_bf16 v[92:95], a[188:191], v[156:159], v[92:95]
  buffer_load_dwordx4 v[156:159], v2, s[76:79], s16 offen offset:3072 sc1
  s_add_u32 s16, s16, 4096
  s_cmp_eq_u32 s16, s3
  s_cselect_b32 s100, 65536, 0
  s_sub_u32 s16, s16, s100
  s_waitcnt vmcnt(12)
  v_mfma_f32_16x16x32_bf16 v[32:35], a[192:195], v[96:99], v[32:35]
  v_mfma_f32_16x16x32_bf16 v[48:51], a[196:199], v[96:99], v[48:51]
  v_mfma_f32_16x16x32_bf16 v[64:67], a[200:203], v[96:99], v[64:67]
  v_mfma_f32_16x16x32_bf16 v[80:83], a[204:207], v[96:99], v[80:83]
  v_mfma_f32_16x16x32_bf16 v[36:39], a[192:195], v[100:103], v[36:39]
  v_mfma_f32_16x16x32_bf16 v[52:55], a[196:199], v[100:103], v[52:55]
  v_mfma_f32_16x16x32_bf16 v[68:71], a[200:203], v[100:103], v[68:71]
  v_mfma_f32_16x16x32_bf16 v[84:87], a[204:207], v[100:103], v[84:87]
  v_mfma_f32_16x16x32_bf16 v[40:43], a[192:195], v[104:107], v[40:43]
  v_mfma_f32_16x16x32_bf16 v[56:59], a[196:199], v[104:107], v[56:59]
  v_mfma_f32_16x16x32_bf16 v[72:75], a[200:203], v[104:107], v[72:75]
  v_mfma_f32_16x16x32_bf16 v[88:91], a[204:207], v[104:107], v[88:91]
  v_mfma_f32_16x16x32_bf16 v[44:47], a[192:195], v[108:111], v[44:47]
  v_mfma_f32_16x16x32_bf16 v[60:63], a[196:199], v[108:111], v[60:63]
  v_mfma_f32_16x16x32_bf16 v[76:79], a[200:203], v[108:111], v[76:79]
  v_mfma_f32_16x16x32_bf16 v[92:95], a[204:207], v[108:111], v[92:95]
  s_lshl_b32 s8, s83, 2
  s_add_u32 s8, s8, s80
  s_lshl_b32 s8, s8, 3
  s_mul_i32 s10, s8, 128
  s_add_u32 s10, s10, 8519680
  v_min_u32 v30, 7, v1
  v_mul_u32_u24 v30, 128, v30
  buffer_load_dword v31, v30, s[76:79], s10 offen sc1
  s_barrier
  s_waitcnt vmcnt(9)
  v_mfma_f32_16x16x32_bf16 v[32:35], a[208:211], v[112:115], v[32:35]
  v_mfma_f32_16x16x32_bf16 v[36:39], a[208:211], v[116:119], v[36:39]
  v_mfma_f32_16x16x32_bf16 v[40:43], a[208:211], v[120:123], v[40:43]
  v_mfma_f32_16x16x32_bf16 v[44:47], a[208:211], v[124:127], v[44:47]
  s_waitcnt vmcnt(5)
  s_add_u32 m0, s96, 0
  s_nop 0
  buffer_load_dwordx4 v172, s[64:67], s97 offen offset:0 lds
  buffer_load_dwordx4 v173, s[64:67], s97 offen offset:1024 lds
  buffer_load_dwordx4 v174, s[64:67], s97 offen offset:2048 lds
  buffer_load_dwordx4 v175, s[64:67], s97 offen offset:3072 lds
  s_add_u32 s97, s97, 131072
  v_mfma_f32_16x16x32_bf16 v[32:35], a[224:227], v[128:131], v[32:35]
  v_mfma_f32_16x16x32_bf16 v[36:39], a[224:227], v[132:135], v[36:39]
  v_mfma_f32_16x16x32_bf16 v[40:43], a[224:227], v[136:139], v[40:43]
  v_mfma_f32_16x16x32_bf16 v[44:47], a[224:227], v[140:143], v[44:47]
  s_waitcnt vmcnt(5)
  s_add_u32 m0, s96, 4096
  s_nop 0
  buffer_load_dwordx4 v172, s[64:67], s97 offen offset:0 lds
  buffer_load_dwordx4 v173, s[64:67], s97 offen offset:1024 lds
  buffer_load_dwordx4 v174, s[64:67], s97 offen offset:2048 lds
  buffer_load_dwordx4 v175, s[64:67], s97 offen offset:3072 lds
  s_add_u32 s97, s97, 131072
  s_cmp_eq_u32 s97, s95
  s_cselect_b32 s100, 1835008, 0
  s_sub_u32 s97, s97, s100
  v_mfma_f32_16x16x32_bf16 v[32:35], a[240:243], v[144:147], v[32:35]
  v_mfma_f32_16x16x32_bf16 v[36:39], a[240:243], v[148:151], v[36:39]
  v_mfma_f32_16x16x32_bf16 v[40:43], a[240:243], v[152:155], v[40:43]
  v_mfma_f32_16x16x32_bf16 v[44:47], a[240:243], v[156:159], v[44:47]
  v_mfma_f32_16x16x32_bf16 v[48:51], a[212:215], v[112:115], v[48:51]
  v_mfma_f32_16x16x32_bf16 v[52:55], a[212:215], v[116:119], v[52:55]
  v_mfma_f32_16x16x32_bf16 v[56:59], a[212:215], v[120:123], v[56:59]
  s_nop 1
  ds_write_b128 v12, v[32:35] offset:0
  v_mfma_f32_16x16x32_bf16 v[60:63], a[212:215], v[124:127], v[60:63]
  v_mfma_f32_16x16x32_bf16 v[48:51], a[228:231], v[128:131], v[48:51]
  ds_write_b128 v12, v[36:39] offset:1024
  v_mfma_f32_16x16x32_bf16 v[52:55], a[228:231], v[132:135], v[52:55]
  v_mfma_f32_16x16x32_bf16 v[56:59], a[228:231], v[136:139], v[56:59]
  ds_write_b128 v12, v[40:43] offset:2048
  v_mfma_f32_16x16x32_bf16 v[60:63], a[228:231], v[140:143], v[60:63]
  v_mfma_f32_16x16x32_bf16 v[48:51], a[244:247], v[144:147], v[48:51]
  ds_write_b128 v12, v[44:47] offset:3072
  v_mfma_f32_16x16x32_bf16 v[52:55], a[244:247], v[148:151], v[52:55]
  v_mfma_f32_16x16x32_bf16 v[56:59], a[244:247], v[152:155], v[56:59]
  v_mfma_f32_16x16x32_bf16 v[60:63], a[244:247], v[156:159], v[60:63]
  v_mfma_f32_16x16x32_bf16 v[64:67], a[216:219], v[112:115], v[64:67]
  v_mfma_f32_16x16x32_bf16 v[68:71], a[216:219], v[116:119], v[68:71]
  v_mfma_f32_16x16x32_bf16 v[72:75], a[216:219], v[120:123], v[72:75]
  s_nop 0
  ds_write_b128 v13, v[48:51] offset:0
  v_mfma_f32_16x16x32_bf16 v[76:79], a[216:219], v[124:127], v[76:79]
  v_mfma_f32_16x16x32_bf16 v[64:67], a[232:235], v[128:131], v[64:67]
  ds_write_b128 v13, v[52:55] offset:1024
  v_mfma_f32_16x16x32_bf16 v[68:71], a[232:235], v[132:135], v[68:71]
  v_mfma_f32_16x16x32_bf16 v[72:75], a[232:235], v[136:139], v[72:75]
  ds_write_b128 v13, v[56:59] offset:2048
  v_mfma_f32_16x16x32_bf16 v[76:79], a[232:235], v[140:143], v[76:79]
  v_mfma_f32_16x16x32_bf16 v[64:67], a[248:251], v[144:147], v[64:67]
  ds_write_b128 v13, v[60:63] offset:3072
  v_mfma_f32_16x16x32_bf16 v[68:71], a[248:251], v[148:151], v[68:71]
  v_mfma_f32_16x16x32_bf16 v[72:75], a[248:251], v[152:155], v[72:75]
  v_mfma_f32_16x16x32_bf16 v[76:79], a[248:251], v[156:159], v[76:79]
  v_mfma_f32_16x16x32_bf16 v[80:83], a[220:223], v[112:115], v[80:83]
  v_mfma_f32_16x16x32_bf16 v[84:87], a[220:223], v[116:119], v[84:87]
  v_mfma_f32_16x16x32_bf16 v[88:91], a[220:223], v[120:123], v[88:91]
  s_nop 0
  ds_write_b128 v14, v[64:67] offset:0
  v_mfma_f32_16x16x32_bf16 v[92:95], a[220:223], v[124:127], v[92:95]
  v_mfma_f32_16x16x32_bf16 v[80:83], a[236:239], v[128:131], v[80:83]
  ds_write_b128 v14, v[68:71] offset:1024
  v_mfma_f32_16x16x32_bf16 v[84:87], a[236:239], v[132:135], v[84:87]
  v_mfma_f32_16x16x32_bf16 v[88:91], a[236:239], v[136:139], v[88:91]
  ds_write_b128 v14, v[72:75] offset:2048
  v_mfma_f32_16x16x32_bf16 v[92:95], a[236:239], v[140:143], v[92:95]
  v_mfma_f32_16x16x32_bf16 v[80:83], a[252:255], v[144:147], v[80:83]
  ds_write_b128 v14, v[76:79] offset:3072
  v_mfma_f32_16x16x32_bf16 v[84:87], a[252:255], v[148:151], v[84:87]
  v_mfma_f32_16x16x32_bf16 v[88:91], a[252:255], v[152:155], v[88:91]
  v_mfma_f32_16x16x32_bf16 v[92:95], a[252:255], v[156:159], v[92:95]
  s_waitcnt vmcnt(8)
  s_mov_b32 s9, 0
P6:
  v_cmp_ne_u32 vcc, s85, v31
  s_nop 4
  s_cbranch_vccz Q7
  s_sleep 4
  buffer_load_dword v31, v30, s[76:79], s10 offen sc1
  s_add_u32 s9, s9, 1
  s_cmp_lt_u32 s9, 0x40000
  s_waitcnt vmcnt(0)
  s_cbranch_scc1 P6
Q7:
  s_waitcnt lgkmcnt(0)
  s_barrier
  ds_read_b128 v[112:115], v15 offset:0
  ds_read_b128 v[116:119], v15 offset:1024
  ds_read_b128 v[120:123], v15 offset:2048
  ds_read_b128 v[124:127], v15 offset:3072
  ds_read_b128 v[128:131], v15 offset:4096
  ds_read_b128 v[132:135], v15 offset:5120
  ds_read_b128 v[136:139], v15 offset:6144
  ds_read_b128 v[140:143], v15 offset:7168
  ds_read_b128 v[144:147], v15 offset:8192
  ds_read_b128 v[148:151], v15 offset:9216
  ds_read_b128 v[152:155], v15 offset:10240
  ds_read_b128 v[156:159], v15 offset:11264
  s_waitcnt lgkmcnt(8)
  v_pk_add_f32 v[96:97], v[80:81], v[112:113]
  v_pk_add_f32 v[98:99], v[82:83], v[114:115]
  v_pk_add_f32 v[100:101], v[84:85], v[116:117]
  v_pk_add_f32 v[102:103], v[86:87], v[118:119]
  v_pk_add_f32 v[104:105], v[88:89], v[120:121]
  v_pk_add_f32 v[106:107], v[90:91], v[122:123]
  v_pk_add_f32 v[108:109], v[92:93], v[124:125]
  v_pk_add_f32 v[110:111], v[94:95], v[126:127]
  s_waitcnt lgkmcnt(4)
  v_pk_add_f32 v[96:97], v[96:97], v[128:129]
  v_pk_add_f32 v[98:99], v[98:99], v[130:131]
  v_pk_add_f32 v[100:101], v[100:101], v[132:133]
  v_pk_add_f32 v[102:103], v[102:103], v[134:135]
  v_pk_add_f32 v[104:105], v[104:105], v[136:137]
  v_pk_add_f32 v[106:107], v[106:107], v[138:139]
  v_pk_add_f32 v[108:109], v[108:109], v[140:141]
  v_pk_add_f32 v[110:111], v[110:111], v[142:143]
  s_waitcnt lgkmcnt(0)
  v_pk_add_f32 v[96:97], v[96:97], v[144:145]
  v_pk_add_f32 v[98:99], v[98:99], v[146:147]
  v_pk_add_f32 v[100:101], v[100:101], v[148:149]
  v_pk_add_f32 v[102:103], v[102:103], v[150:151]
  v_pk_add_f32 v[104:105], v[104:105], v[152:153]
  v_pk_add_f32 v[106:107], v[106:107], v[154:155]
  v_pk_add_f32 v[108:109], v[108:109], v[156:157]
  v_pk_add_f32 v[110:111], v[110:111], v[158:159]
  s_lshl_b32 s8, s83, 6
  s_lshl_b32 s9, s84, 1
  s_add_u32 s8, s8, s9
  s_lshr_b32 s9, s80, 1
  s_add_u32 s8, s8, s9
  s_mul_i32 s8, s8, 4096
  s_and_b32 s9, s80, 1
  s_lshl_b32 s9, s9, 11
  s_add_u32 s8, s8, s9
  s_add_u32 s8, s8, 4194304
  buffer_load_dwordx4 v[240:243], v2, s[76:79], s8 offen sc1
  buffer_load_dwordx4 v[244:247], v2, s[76:79], s8 offen offset:1024 sc1
  v_cvt_pk_bf16_f32 v96, 0, v96
  v_cvt_pk_bf16_f32 v97, 0, v97
  v_cvt_pk_bf16_f32 v98, 0, v98
  v_cvt_pk_bf16_f32 v99, 0, v99
  v_cvt_pk_bf16_f32 v100, 0, v100
  v_cvt_pk_bf16_f32 v101, 0, v101
  v_cvt_pk_bf16_f32 v102, 0, v102
  v_cvt_pk_bf16_f32 v103, 0, v103
  v_cvt_pk_bf16_f32 v104, 0, v104
  v_cvt_pk_bf16_f32 v105, 0, v105
  v_cvt_pk_bf16_f32 v106, 0, v106
  v_cvt_pk_bf16_f32 v107, 0, v107
  v_cvt_pk_bf16_f32 v108, 0, v108
  v_cvt_pk_bf16_f32 v109, 0, v109
  v_cvt_pk_bf16_f32 v110, 0, v110
  v_cvt_pk_bf16_f32 v111, 0, v111
  v_pk_add_f32 v[96:97], v[96:97], v[160:161]
  v_pk_add_f32 v[98:99], v[98:99], v[162:163]
  v_pk_add_f32 v[100:101], v[100:101], v[160:161]
  v_pk_add_f32 v[102:103], v[102:103], v[162:163]
  v_pk_add_f32 v[104:105], v[104:105], v[160:161]
  v_pk_add_f32 v[106:107], v[106:107], v[162:163]
  v_pk_add_f32 v[108:109], v[108:109], v[160:161]
  v_pk_add_f32 v[110:111], v[110:111], v[162:163]
  v_cvt_pk_bf16_f32 v96, 0, v96
  v_cvt_pk_bf16_f32 v97, 0, v97
  v_cvt_pk_bf16_f32 v98, 0, v98
  v_cvt_pk_bf16_f32 v99, 0, v99
  v_cvt_pk_bf16_f32 v100, 0, v100
  v_cvt_pk_bf16_f32 v101, 0, v101
  v_cvt_pk_bf16_f32 v102, 0, v102
  v_cvt_pk_bf16_f32 v103, 0, v103
  v_cvt_pk_bf16_f32 v104, 0, v104
  v_cvt_pk_bf16_f32 v105, 0, v105
  v_cvt_pk_bf16_f32 v106, 0, v106
  v_cvt_pk_bf16_f32 v107, 0, v107
  v_cvt_pk_bf16_f32 v108, 0, v108
  v_cvt_pk_bf16_f32 v109, 0, v109
  v_cvt_pk_bf16_f32 v110, 0, v110
  v_cvt_pk_bf16_f32 v111, 0, v111
  v_pk_mul_f32 v[112:113], v[96:97], v[96:97]
  v_pk_mul_f32 v[114:115], v[98:99], v[98:99]
  v_pk_mul_f32 v[116:117], v[100:101], v[100:101]
  v_pk_mul_f32 v[118:119], v[102:103], v[102:103]
  v_pk_mul_f32 v[120:121], v[104:105], v[104:105]
  v_pk_mul_f32 v[122:123], v[106:107], v[106:107]
  v_pk_mul_f32 v[124:125], v[108:109], v[108:109]
  v_pk_mul_f32 v[126:127], v[110:111], v[110:111]
  v_pk_fma_f32 v[112:113], v[112:113], v[164:165], v[164:165] op_sel:[0,1,0] op_sel_hi:[1,1,0]
  v_pk_fma_f32 v[114:115], v[114:115], v[164:165], v[164:165] op_sel:[0,1,0] op_sel_hi:[1,1,0]
  v_pk_fma_f32 v[116:117], v[116:117], v[164:165], v[164:165] op_sel:[0,1,0] op_sel_hi:[1,1,0]
  v_pk_fma_f32 v[118:119], v[118:119], v[164:165], v[164:165] op_sel:[0,1,0] op_sel_hi:[1,1,0]
  v_pk_fma_f32 v[120:121], v[120:121], v[164:165], v[164:165] op_sel:[0,1,0] op_sel_hi:[1,1,0]
  v_pk_fma_f32 v[122:123], v[122:123], v[164:165], v[164:165] op_sel:[0,1,0] op_sel_hi:[1,1,0]
  v_pk_fma_f32 v[124:125], v[124:125], v[164:165], v[164:165] op_sel:[0,1,0] op_sel_hi:[1,1,0]
  v_pk_fma_f32 v[126:127], v[126:127], v[164:165], v[164:165] op_sel:[0,1,0] op_sel_hi:[1,1,0]
  v_pk_mul_f32 v[112:113], v[112:113], v[96:97]
  v_pk_mul_f32 v[114:115], v[114:115], v[98:99]
  v_pk_mul_f32 v[116:117], v[116:117], v[100:101]
  v_pk_mul_f32 v[118:119], v[118:119], v[102:103]
  v_pk_mul_f32 v[120:121], v[120:121], v[104:105]
  v_pk_mul_f32 v[122:123], v[122:123], v[106:107]
  v_pk_mul_f32 v[124:125], v[124:125], v[108:109]
  v_pk_mul_f32 v[126:127], v[126:127], v[110:111]
  v_exp_f32 v112, v112
  v_exp_f32 v113, v113
  v_exp_f32 v114, v114
  v_exp_f32 v115, v115
  v_exp_f32 v116, v116
  v_exp_f32 v117, v117
  v_exp_f32 v118, v118
  v_exp_f32 v119, v119
  v_exp_f32 v120, v120
  v_exp_f32 v121, v121
  v_exp_f32 v122, v122
  v_exp_f32 v123, v123
  v_exp_f32 v124, v124
  v_exp_f32 v125, v125
  v_exp_f32 v126, v126
  v_exp_f32 v127, v127
  v_pk_add_f32 v[112:113], v[112:113], 1.0 op_sel_hi:[1,0]
  v_pk_add_f32 v[114:115], v[114:115], 1.0 op_sel_hi:[1,0]
  v_pk_add_f32 v[116:117], v[116:117], 1.0 op_sel_hi:[1,0]
  v_pk_add_f32 v[118:119], v[118:119], 1.0 op_sel_hi:[1,0]
  v_pk_add_f32 v[120:121], v[120:121], 1.0 op_sel_hi:[1,0]
  v_pk_add_f32 v[122:123], v[122:123], 1.0 op_sel_hi:[1,0]
  v_pk_add_f32 v[124:125], v[124:125], 1.0 op_sel_hi:[1,0]
  v_pk_add_f32 v[126:127], v[126:127], 1.0 op_sel_hi:[1,0]
  v_rcp_f32 v112, v112
  v_rcp_f32 v113, v113
  v_rcp_f32 v114, v114
  v_rcp_f32 v115, v115
  v_rcp_f32 v116, v116
  v_rcp_f32 v117, v117
  v_rcp_f32 v118, v118
  v_rcp_f32 v119, v119
  v_rcp_f32 v120, v120
  v_rcp_f32 v121, v121
  v_rcp_f32 v122, v122
  v_rcp_f32 v123, v123
  v_rcp_f32 v124, v124
  v_rcp_f32 v125, v125
  v_rcp_f32 v126, v126
  v_rcp_f32 v127, v127
  v_pk_mul_f32 v[96:97], v[96:97], v[112:113]
  v_pk_mul_f32 v[98:99], v[98:99], v[114:115]
  v_pk_mul_f32 v[100:101], v[100:101], v[116:117]
  v_pk_mul_f32 v[102:103], v[102:103], v[118:119]
  v_cvt_pk_bf16_f32 v128, v96, v97
  v_cvt_pk_bf16_f32 v129, v98, v99
  v_cvt_pk_bf16_f32 v130, v100, v101
  v_cvt_pk_bf16_f32 v131, v102, v103
  s_nop 0
  v_permlane16_swap_b32 v128, v130
  v_permlane16_swap_b32 v129, v131
  buffer_store_dwordx4 v[128:131], v9, s[76:79], s17 offen offset:0 sc1
  v_pk_mul_f32 v[104:105], v[104:105], v[120:121]
  v_pk_mul_f32 v[106:107], v[106:107], v[122:123]
  v_pk_mul_f32 v[108:109], v[108:109], v[124:125]
  v_pk_mul_f32 v[110:111], v[110:111], v[126:127]
  v_cvt_pk_bf16_f32 v132, v104, v105
  v_cvt_pk_bf16_f32 v133, v106, v107
  v_cvt_pk_bf16_f32 v134, v108, v109
  v_cvt_pk_bf16_f32 v135, v110, v111
  s_nop 0
  v_permlane16_swap_b32 v132, v134
  v_permlane16_swap_b32 v133, v135
  buffer_store_dwordx4 v[132:135], v9, s[76:79], s17 offen offset:2048 sc1
  v_and_b32 v19, 3, v1
  v_lshlrev_b32 v22, 4, v19
  v_sub_u32 v22, 48, v22
  v_lshlrev_b64 v[26:27], v22, v[20:21]
  v_lshlrev_b64 v[26:27], 16, v[26:27]
  v_mov_b64 v[20:21], 0
  v_mov_b64 v[22:23], 0
  v_mov_b64 v[24:25], 0
  v_and_b32 v19, 7, v1
  v_mul_u32_u24 v19, 4160, v19
  s_mov_b64 exec, 0xff
  ds_write_b128 v19, v[20:23] offset:0
  ds_write_b128 v19, v[24:27] offset:16
  s_mov_b64 exec, -1
  s_and_b32 s15, s80, 1
  s_lshl_b32 s12, s80, 12
  s_add_u32 s12, s12, 0
  v_add_u32 v25, s12, v2
  s_xor_b32 s12, s80, 1
  s_lshl_b32 s12, s12, 12
  s_add_u32 s12, s12, 0
  v_add_u32 v26, s12, v2
  v_bfe_u32 v27, v1, 4, 1
  v_lshlrev_b32 v27, 9, v27
  v_and_b32 v17, 15, v1
  v_lshl_add_u32 v27, v17, 5, v27
  v_lshrrev_b32 v17, 5, v1
  v_lshl_add_u32 v27, v17, 4, v27
  s_lshl_b32 s12, s83, 6
  s_lshl_b32 s9, s84, 1
  s_add_u32 s12, s12, s9
  s_lshr_b32 s9, s80, 1
  s_add_u32 s12, s12, s9
  s_mul_i32 s12, s12, 4096
  s_lshl_b32 s9, s15, 11
  s_add_u32 s12, s12, s9
  s_add_u32 s12, s12, 6291456
  v_and_b32 v17, 15, v1
  v_bfe_u32 v18, v1, 4, 1
  v_lshrrev_b32 v16, 5, v1
  v_lshlrev_b32 v18, 5, v18
  v_lshl_add_u32 v18, v16, 4, v18
  v_mul_u32_u24 v16, 896, v17
  v_add_u32 v10, v16, v18
  v_lshlrev_b32 v160, 3, v17
  v_lshlrev_b32 v161, 1, v17
  v_mul_u32_u24 v4, 2048, v18
  v_add_u32 v4, v4, v161
  s_lshl_b32 s14, s84, 6
  s_lshl_b32 s9, s80, 4
  s_add_u32 s14, s14, s9
  s_mul_i32 s99, s14, 896
  s_lshl_b32 s9, s83, 7
  s_add_u32 s99, s99, s9
  s_lshl_b32 s13, s14, 3
  s_add_u32 s13, s13, 8388608
  s_lshl_b32 s14, s14, 1
  s_waitcnt vmcnt(2)
  s_lshr_b32 s8, s80, 1
  s_mul_i32 s8, s8, 4608
  s_and_b32 s9, s80, 1
  s_lshl_b32 s10, s9, 11
  s_add_u32 s10, s10, s8
  v_add_u32 v19, s10, v2
  ds_write_b128 v19, v[240:243] offset:33280
  ds_write_b128 v19, v[244:247] offset:34304
  s_lshl_b32 s9, s9, 8
  s_add_u32 s8, s8, s9
  v_add_u32 v19, s8, v2
  v_mov_b64 v[20:21], 0
  v_mov_b64 v[22:23], 0
  s_mov_b64 exec, 0xffff
  ds_write_b128 v19, v[20:23] offset:37376
  s_mov_b64 exec, -1
  s_mul_i32 s17, s81, 28
  s_add_u32 s17, s17, s82
  s_branch COMMON
ROLEBC:
  s_cmp_ge_u32 s98, 7
  s_cbranch_scc1 L8
  v_add_u32 v18, 456064, v21
  buffer_load_dwordx4 v[124:127], v18, s[36:39], 0 offen
  v_add_u32 v18, 456960, v21
  buffer_load_dwordx4 v[128:131], v18, s[36:39], 0 offen
  v_add_u32 v18, 457856, v21
  buffer_load_dwordx4 v[132:135], v18, s[36:39], 0 offen
  v_add_u32 v18, 458752, v21
  buffer_load_dwordx4 v[136:139], v18, s[36:39], 0 offen
  buffer_load_dwordx4 v[144:147], v18, s[40:43], 0 offen
  v_add_u32 v18, 459648, v21
  buffer_load_dwordx4 v[140:143], v18, s[36:39], 0 offen
  buffer_load_dwordx4 v[148:151], v18, s[40:43], 0 offen
  s_waitcnt vmcnt(11)
  v_lshlrev_b32 v208, 16, v180
  v_and_b32 v216, 0xffff0000, v180
  v_lshlrev_b32 v224, 16, v181
  v_and_b32 v232, 0xffff0000, v181
  v_lshlrev_b32 v209, 16, v182
  v_and_b32 v217, 0xffff0000, v182
  v_lshlrev_b32 v225, 16, v183
  v_and_b32 v233, 0xffff0000, v183
  v_lshlrev_b32 v210, 16, v184
  v_and_b32 v218, 0xffff0000, v184
  v_lshlrev_b32 v226, 16, v185
  v_and_b32 v234, 0xffff0000, v185
  v_lshlrev_b32 v211, 16, v186
  v_and_b32 v219, 0xffff0000, v186
  v_lshlrev_b32 v227, 16, v187
  v_and_b32 v235, 0xffff0000, v187
  v_lshlrev_b32 v212, 16, v188
  v_and_b32 v220, 0xffff0000, v188
  v_lshlrev_b32 v228, 16, v189
  v_and_b32 v236, 0xffff0000, v189
  v_lshlrev_b32 v213, 16, v190
  v_and_b32 v221, 0xffff0000, v190
  v_lshlrev_b32 v229, 16, v191
  v_and_b32 v237, 0xffff0000, v191
  v_lshlrev_b32 v214, 16, v192
  v_and_b32 v222, 0xffff0000, v192
  v_lshlrev_b32 v230, 16, v193
  v_and_b32 v238, 0xffff0000, v193
  v_lshlrev_b32 v215, 16, v194
  v_and_b32 v223, 0xffff0000, v194
  v_lshlrev_b32 v231, 16, v195
  v_and_b32 v239, 0xffff0000, v195
  v_lshlrev_b32 v32, 16, v96
  v_and_b32 v33, 0xffff0000, v96
  v_lshlrev_b32 v34, 16, v97
  v_and_b32 v35, 0xffff0000, v97
  v_lshlrev_b32 v36, 16, v98
  v_and_b32 v37, 0xffff0000, v98
  v_lshlrev_b32 v38, 16, v99
  v_and_b32 v39, 0xffff0000, v99
  v_lshlrev_b32 v40, 16, v100
  v_and_b32 v41, 0xffff0000, v100
  v_lshlrev_b32 v42, 16, v101
  v_and_b32 v43, 0xffff0000, v101
  v_lshlrev_b32 v44, 16, v102
  v_and_b32 v45, 0xffff0000, v102
  v_lshlrev_b32 v46, 16, v103
  v_and_b32 v47, 0xffff0000, v103
  v_lshlrev_b32 v48, 16, v104
  v_and_b32 v49, 0xffff0000, v104
  v_lshlrev_b32 v50, 16, v105
  v_and_b32 v51, 0xffff0000, v105
  v_lshlrev_b32 v52, 16, v106
  v_and_b32 v53, 0xffff0000, v106
  v_lshlrev_b32 v54, 16, v107
  v_and_b32 v55, 0xffff0000, v107
  v_lshlrev_b32 v56, 16, v108
  v_and_b32 v57, 0xffff0000, v108
  v_lshlrev_b32 v58, 16, v109
  v_and_b32 v59, 0xffff0000, v109
  v_lshlrev_b32 v60, 16, v110
  v_and_b32 v61, 0xffff0000, v110
  v_lshlrev_b32 v62, 16, v111
  v_and_b32 v63, 0xffff0000, v111
  v_lshlrev_b32 v64, 16, v112
  v_and_b32 v65, 0xffff0000, v112
  v_lshlrev_b32 v66, 16, v113
  v_and_b32 v67, 0xffff0000, v113
  v_lshlrev_b32 v68, 16, v114
  v_and_b32 v69, 0xffff0000, v114
  v_lshlrev_b32 v70, 16, v115
  v_and_b32 v71, 0xffff0000, v115
  v_pk_mul_f32 v[240:241], v[32:33], v[232:233]
  v_pk_mul_f32 v[242:243], v[34:35], v[234:235]
  v_pk_mul_f32 v[244:245], v[36:37], v[236:237]
  v_pk_mul_f32 v[246:247], v[38:39], v[238:239]
  v_pk_mul_f32 v[248:249], v[40:41], v[232:233]
  v_pk_mul_f32 v[250:251], v[42:43], v[234:235]
  v_pk_mul_f32 v[252:253], v[44:45], v[236:237]
  v_pk_mul_f32 v[254:255], v[46:47], v[238:239]
  v_cvt_pk_bf16_f32 v240, 0, v240
  v_cvt_pk_bf16_f32 v241, 0, v241
  v_cvt_pk_bf16_f32 v242, 0, v242
  v_cvt_pk_bf16_f32 v243, 0, v243
  v_cvt_pk_bf16_f32 v244, 0, v244
  v_cvt_pk_bf16_f32 v245, 0, v245
  v_cvt_pk_bf16_f32 v246, 0, v246
  v_cvt_pk_bf16_f32 v247, 0, v247
  v_cvt_pk_bf16_f32 v248, 0, v248
  v_cvt_pk_bf16_f32 v249, 0, v249
  v_cvt_pk_bf16_f32 v250, 0, v250
  v_cvt_pk_bf16_f32 v251, 0, v251
  v_cvt_pk_bf16_f32 v252, 0, v252
  v_cvt_pk_bf16_f32 v253, 0, v253
  v_cvt_pk_bf16_f32 v254, 0, v254
  v_cvt_pk_bf16_f32 v255, 0, v255
  v_pk_mul_f32 v[72:73], v[40:41], v[224:225]
  v_pk_mul_f32 v[74:75], v[42:43], v[226:227]
  v_pk_mul_f32 v[76:77], v[44:45], v[228:229]
  v_pk_mul_f32 v[78:79], v[46:47], v[230:231]
  v_pk_mul_f32 v[80:81], v[48:49], v[224:225]
  v_pk_mul_f32 v[82:83], v[50:51], v[226:227]
  v_pk_mul_f32 v[84:85], v[52:53], v[228:229]
  v_pk_mul_f32 v[86:87], v[54:55], v[230:231]
  v_cvt_pk_bf16_f32 v72, 0, v72
  v_cvt_pk_bf16_f32 v73, 0, v73
  v_cvt_pk_bf16_f32 v74, 0, v74
  v_cvt_pk_bf16_f32 v75, 0, v75
  v_cvt_pk_bf16_f32 v76, 0, v76
  v_cvt_pk_bf16_f32 v77, 0, v77
  v_cvt_pk_bf16_f32 v78, 0, v78
  v_cvt_pk_bf16_f32 v79, 0, v79
  v_cvt_pk_bf16_f32 v80, 0, v80
  v_cvt_pk_bf16_f32 v81, 0, v81
  v_cvt_pk_bf16_f32 v82, 0, v82
  v_cvt_pk_bf16_f32 v83, 0, v83
  v_cvt_pk_bf16_f32 v84, 0, v84
  v_cvt_pk_bf16_f32 v85, 0, v85
  v_cvt_pk_bf16_f32 v86, 0, v86
  v_cvt_pk_bf16_f32 v87, 0, v87
  v_pk_add_f32 v[240:241], v[240:241], v[72:73]
  v_pk_add_f32 v[242:243], v[242:243], v[74:75]
  v_pk_add_f32 v[244:245], v[244:245], v[76:77]
  v_pk_add_f32 v[246:247], v[246:247], v[78:79]
  v_pk_add_f32 v[248:249], v[248:249], v[80:81]
  v_pk_add_f32 v[250:251], v[250:251], v[82:83]
  v_pk_add_f32 v[252:253], v[252:253], v[84:85]
  v_pk_add_f32 v[254:255], v[254:255], v[86:87]
  s_waitcnt vmcnt(7)
  s_mov_b32 s8, s2
  s_mul_i32 s8, s8, 16
  s_add_u32 s8, s8, 8454144
  s_cmp_eq_u32 s80, 0
  s_cselect_b32 s8, s8, 1073741824
  v_mov_b32 v30, s85
  v_mov_b32 v31, 0
  s_barrier
  s_mov_b64 exec, 1
  buffer_store_dword v30, v31, s[76:79], s8 offen sc1
  s_mov_b64 exec, -1
  v_add_u32 v18, 914816, v21
  buffer_load_dwordx4 v[152:155], v18, s[36:39], 0 offen
  v_add_u32 v18, 915712, v21
  buffer_load_dwordx4 v[156:159], v18, s[36:39], 0 offen
  v_add_u32 v18, 916608, v21
  buffer_load_dwordx4 v[160:163], v18, s[36:39], 0 offen
  v_add_u32 v18, 917504, v21
  buffer_load_dwordx4 v[164:167], v18, s[36:39], 0 offen
  buffer_load_dwordx4 v[172:175], v18, s[40:43], 0 offen
  v_add_u32 v18, 918400, v21
  buffer_load_dwordx4 v[168:171], v18, s[36:39], 0 offen
  buffer_load_dwordx4 v[176:179], v18, s[40:43], 0 offen
  v_cvt_pk_bf16_f32 v240, 0, v240
  v_cvt_pk_bf16_f32 v241, 0, v241
  v_cvt_pk_bf16_f32 v242, 0, v242
  v_cvt_pk_bf16_f32 v243, 0, v243
  v_cvt_pk_bf16_f32 v244, 0, v244
  v_cvt_pk_bf16_f32 v245, 0, v245
  v_cvt_pk_bf16_f32 v246, 0, v246
  v_cvt_pk_bf16_f32 v247, 0, v247
  v_cvt_pk_bf16_f32 v248, 0, v248
  v_cvt_pk_bf16_f32 v249, 0, v249
  v_cvt_pk_bf16_f32 v250, 0, v250
  v_cvt_pk_bf16_f32 v251, 0, v251
  v_cvt_pk_bf16_f32 v252, 0, v252
  v_cvt_pk_bf16_f32 v253, 0, v253
  v_cvt_pk_bf16_f32 v254, 0, v254
  v_cvt_pk_bf16_f32 v255, 0, v255
  v_pk_mul_f32 v[72:73], v[48:49], v[216:217]
  v_pk_mul_f32 v[74:75], v[50:51], v[218:219]
  v_pk_mul_f32 v[76:77], v[52:53], v[220:221]
  v_pk_mul_f32 v[78:79], v[54:55], v[222:223]
  v_pk_mul_f32 v[80:81], v[56:57], v[216:217]
  v_pk_mul_f32 v[82:83], v[58:59], v[218:219]
  v_pk_mul_f32 v[84:85], v[60:61], v[220:221]
  v_pk_mul_f32 v[86:87], v[62:63], v[222:223]
  v_cvt_pk_bf16_f32 v72, 0, v72
  v_cvt_pk_bf16_f32 v73, 0, v73
  v_cvt_pk_bf16_f32 v74, 0, v74
  v_cvt_pk_bf16_f32 v75, 0, v75
  v_cvt_pk_bf16_f32 v76, 0, v76
  v_cvt_pk_bf16_f32 v77, 0, v77
  v_cvt_pk_bf16_f32 v78, 0, v78
  v_cvt_pk_bf16_f32 v79, 0, v79
  v_cvt_pk_bf16_f32 v80, 0, v80
  v_cvt_pk_bf16_f32 v81, 0, v81
  v_cvt_pk_bf16_f32 v82, 0, v82
  v_cvt_pk_bf16_f32 v83, 0, v83
  v_cvt_pk_bf16_f32 v84, 0, v84
  v_cvt_pk_bf16_f32 v85, 0, v85
  v_cvt_pk_bf16_f32 v86, 0, v86
  v_cvt_pk_bf16_f32 v87, 0, v87
  v_pk_add_f32 v[240:241], v[240:241], v[72:73]
  v_pk_add_f32 v[242:243], v[242:243], v[74:75]
  v_pk_add_f32 v[244:245], v[244:245], v[76:77]
  v_pk_add_f32 v[246:247], v[246:247], v[78:79]
  v_pk_add_f32 v[248:249], v[248:249], v[80:81]
  v_pk_add_f32 v[250:251], v[250:251], v[82:83]
  v_pk_add_f32 v[252:253], v[252:253], v[84:85]
  v_pk_add_f32 v[254:255], v[254:255], v[86:87]
  v_cvt_pk_bf16_f32 v240, 0, v240
  v_cvt_pk_bf16_f32 v241, 0, v241
  v_cvt_pk_bf16_f32 v242, 0, v242
  v_cvt_pk_bf16_f32 v243, 0, v243
  v_cvt_pk_bf16_f32 v244, 0, v244
  v_cvt_pk_bf16_f32 v245, 0, v245
  v_cvt_pk_bf16_f32 v246, 0, v246
  v_cvt_pk_bf16_f32 v247, 0, v247
  v_cvt_pk_bf16_f32 v248, 0, v248
  v_cvt_pk_bf16_f32 v249, 0, v249
  v_cvt_pk_bf16_f32 v250, 0, v250
  v_cvt_pk_bf16_f32 v251, 0, v251
  v_cvt_pk_bf16_f32 v252, 0, v252
  v_cvt_pk_bf16_f32 v253, 0, v253
  v_cvt_pk_bf16_f32 v254, 0, v254
  v_cvt_pk_bf16_f32 v255, 0, v255
  v_pk_mul_f32 v[72:73], v[56:57], v[208:209]
  v_pk_mul_f32 v[74:75], v[58:59], v[210:211]
  v_pk_mul_f32 v[76:77], v[60:61], v[212:213]
  v_pk_mul_f32 v[78:79], v[62:63], v[214:215]
  v_pk_mul_f32 v[80:81], v[64:65], v[208:209]
  v_pk_mul_f32 v[82:83], v[66:67], v[210:211]
  v_pk_mul_f32 v[84:85], v[68:69], v[212:213]
  v_pk_mul_f32 v[86:87], v[70:71], v[214:215]
  v_cvt_pk_bf16_f32 v72, 0, v72
  v_cvt_pk_bf16_f32 v73, 0, v73
  v_cvt_pk_bf16_f32 v74, 0, v74
  v_cvt_pk_bf16_f32 v75, 0, v75
  v_cvt_pk_bf16_f32 v76, 0, v76
  v_cvt_pk_bf16_f32 v77, 0, v77
  v_cvt_pk_bf16_f32 v78, 0, v78
  v_cvt_pk_bf16_f32 v79, 0, v79
  v_cvt_pk_bf16_f32 v80, 0, v80
  v_cvt_pk_bf16_f32 v81, 0, v81
  v_cvt_pk_bf16_f32 v82, 0, v82
  v_cvt_pk_bf16_f32 v83, 0, v83
  v_cvt_pk_bf16_f32 v84, 0, v84
  v_cvt_pk_bf16_f32 v85, 0, v85
  v_cvt_pk_bf16_f32 v86, 0, v86
  v_cvt_pk_bf16_f32 v87, 0, v87
  v_pk_add_f32 v[240:241], v[240:241], v[72:73]
  v_pk_add_f32 v[242:243], v[242:243], v[74:75]
  v_pk_add_f32 v[244:245], v[244:245], v[76:77]
  v_pk_add_f32 v[246:247], v[246:247], v[78:79]
  v_pk_add_f32 v[248:249], v[248:249], v[80:81]
  v_pk_add_f32 v[250:251], v[250:251], v[82:83]
  v_pk_add_f32 v[252:253], v[252:253], v[84:85]
  v_pk_add_f32 v[254:255], v[254:255], v[86:87]
  v_cvt_pk_bf16_f32 v240, 0, v240
  v_cvt_pk_bf16_f32 v241, 0, v241
  v_cvt_pk_bf16_f32 v242, 0, v242
  v_cvt_pk_bf16_f32 v243, 0, v243
  v_cvt_pk_bf16_f32 v244, 0, v244
  v_cvt_pk_bf16_f32 v245, 0, v245
  v_cvt_pk_bf16_f32 v246, 0, v246
  v_cvt_pk_bf16_f32 v247, 0, v247
  v_cvt_pk_bf16_f32 v248, 0, v248
  v_cvt_pk_bf16_f32 v249, 0, v249
  v_cvt_pk_bf16_f32 v250, 0, v250
  v_cvt_pk_bf16_f32 v251, 0, v251
  v_cvt_pk_bf16_f32 v252, 0, v252
  v_cvt_pk_bf16_f32 v253, 0, v253
  v_cvt_pk_bf16_f32 v254, 0, v254
  v_cvt_pk_bf16_f32 v255, 0, v255
  v_lshlrev_b32 v72, 16, v116
  v_and_b32 v73, 0xffff0000, v116
  v_lshlrev_b32 v74, 16, v117
  v_and_b32 v75, 0xffff0000, v117
  v_lshlrev_b32 v76, 16, v118
  v_and_b32 v77, 0xffff0000, v118
  v_lshlrev_b32 v78, 16, v119
  v_and_b32 v79, 0xffff0000, v119
  v_lshlrev_b32 v80, 16, v120
  v_and_b32 v81, 0xffff0000, v120
  v_lshlrev_b32 v82, 16, v121
  v_and_b32 v83, 0xffff0000, v121
  v_lshlrev_b32 v84, 16, v122
  v_and_b32 v85, 0xffff0000, v122
  v_lshlrev_b32 v86, 16, v123
  v_and_b32 v87, 0xffff0000, v123
  v_pk_mul_f32 v[240:241], v[240:241], v[72:73]
  v_pk_mul_f32 v[242:243], v[242:243], v[74:75]
  v_pk_mul_f32 v[244:245], v[244:245], v[76:77]
  v_pk_mul_f32 v[246:247], v[246:247], v[78:79]
  v_pk_mul_f32 v[248:249], v[248:249], v[80:81]
  v_pk_mul_f32 v[250:251], v[250:251], v[82:83]
  v_pk_mul_f32 v[252:253], v[252:253], v[84:85]
  v_pk_mul_f32 v[254:255], v[254:255], v[86:87]
  v_cvt_pk_bf16_f32 v96, v240, v241
  v_cvt_pk_bf16_f32 v97, v242, v243
  v_cvt_pk_bf16_f32 v98, v244, v245
  v_cvt_pk_bf16_f32 v99, v246, v247
  v_cvt_pk_bf16_f32 v100, v248, v249
  v_cvt_pk_bf16_f32 v101, v250, v251
  v_cvt_pk_bf16_f32 v102, v252, v253
  v_cvt_pk_bf16_f32 v103, v254, v255
  v_add_u32 v18, 1373568, v21
  buffer_load_dwordx4 v[180:183], v18, s[36:39], 0 offen
  v_add_u32 v18, 1374464, v21
  buffer_load_dwordx4 v[184:187], v18, s[36:39], 0 offen
  v_add_u32 v18, 1375360, v21
  buffer_load_dwordx4 v[188:191], v18, s[36:39], 0 offen
  v_add_u32 v18, 1376256, v21
  buffer_load_dwordx4 v[192:195], v18, s[36:39], 0 offen
  buffer_load_dwordx4 v[200:203], v18, s[40:43], 0 offen
  v_add_u32 v18, 1377152, v21
  buffer_load_dwordx4 v[196:199], v18, s[36:39], 0 offen
  buffer_load_dwordx4 v[204:207], v18, s[40:43], 0 offen
  s_lshl_b32 s8, s80, 3
  s_add_u32 s8, s8, s14
  v_lshlrev_b32 v25, 7, v1
  s_lshl_b32 s8, s8, 13
  buffer_load_dword v26, v25, s[48:51], s8 offen
  ds_write_b128 v22, v[96:99] offset:0
  ds_write_b128 v22, v[100:103] offset:144
  s_waitcnt lgkmcnt(0)
  s_barrier
  ds_read_b64_tr_b16 v[88:89], v23 offset:576
  ds_read_b64_tr_b16 v[90:91], v23 offset:0
  ds_read_b64_tr_b16 v[92:93], v23 offset:592
  ds_read_b64_tr_b16 v[94:95], v23 offset:16
  s_waitcnt vmcnt(16)
  v_lshlrev_b32 v32, 16, v124
  v_and_b32 v33, 0xffff0000, v124
  v_lshlrev_b32 v34, 16, v125
  v_and_b32 v35, 0xffff0000, v125
  v_lshlrev_b32 v36, 16, v126
  v_and_b32 v37, 0xffff0000, v126
  v_lshlrev_b32 v38, 16, v127
  v_and_b32 v39, 0xffff0000, v127
  v_lshlrev_b32 v40, 16, v128
  v_and_b32 v41, 0xffff0000, v128
  v_lshlrev_b32 v42, 16, v129
  v_and_b32 v43, 0xffff0000, v129
  v_lshlrev_b32 v44, 16, v130
  v_and_b32 v45, 0xffff0000, v130
  v_lshlrev_b32 v46, 16, v131
  v_and_b32 v47, 0xffff0000, v131
  v_lshlrev_b32 v48, 16, v132
  v_and_b32 v49, 0xffff0000, v132
  v_lshlrev_b32 v50, 16, v133
  v_and_b32 v51, 0xffff0000, v133
  v_lshlrev_b32 v52, 16, v134
  v_and_b32 v53, 0xffff0000, v134
  v_lshlrev_b32 v54, 16, v135
  v_and_b32 v55, 0xffff0000, v135
  s_waitcnt lgkmcnt(0)
  buffer_store_dwordx4 v[88:91], v24, s[76:79], s13 offen sc1
  v_lshlrev_b32 v56, 16, v136
  v_and_b32 v57, 0xffff0000, v136
  v_lshlrev_b32 v58, 16, v137
  v_and_b32 v59, 0xffff0000, v137
  v_lshlrev_b32 v60, 16, v138
  v_and_b32 v61, 0xffff0000, v138
  v_lshlrev_b32 v62, 16, v139
  v_and_b32 v63, 0xffff0000, v139
  v_lshlrev_b32 v64, 16, v140
  v_and_b32 v65, 0xffff0000, v140
  v_lshlrev_b32 v66, 16, v141
  v_and_b32 v67, 0xffff0000, v141
  v_lshlrev_b32 v68, 16, v142
  v_and_b32 v69, 0xffff0000, v142
  v_lshlrev_b32 v70, 16, v143
  v_and_b32 v71, 0xffff0000, v143
  v_pk_mul_f32 v[240:241], v[32:33], v[232:233]
  v_pk_mul_f32 v[242:243], v[34:35], v[234:235]
  v_pk_mul_f32 v[244:245], v[36:37], v[236:237]
  v_pk_mul_f32 v[246:247], v[38:39], v[238:239]
  v_pk_mul_f32 v[248:249], v[40:41], v[232:233]
  v_pk_mul_f32 v[250:251], v[42:43], v[234:235]
  v_pk_mul_f32 v[252:253], v[44:45], v[236:237]
  v_pk_mul_f32 v[254:255], v[46:47], v[238:239]
  v_cvt_pk_bf16_f32 v240, 0, v240
  v_cvt_pk_bf16_f32 v241, 0, v241
  v_cvt_pk_bf16_f32 v242, 0, v242
  v_cvt_pk_bf16_f32 v243, 0, v243
  v_cvt_pk_bf16_f32 v244, 0, v244
  v_cvt_pk_bf16_f32 v245, 0, v245
  v_cvt_pk_bf16_f32 v246, 0, v246
  v_cvt_pk_bf16_f32 v247, 0, v247
  v_cvt_pk_bf16_f32 v248, 0, v248
  v_cvt_pk_bf16_f32 v249, 0, v249
  v_cvt_pk_bf16_f32 v250, 0, v250
  v_cvt_pk_bf16_f32 v251, 0, v251
  v_cvt_pk_bf16_f32 v252, 0, v252
  v_cvt_pk_bf16_f32 v253, 0, v253
  v_cvt_pk_bf16_f32 v254, 0, v254
  v_cvt_pk_bf16_f32 v255, 0, v255
  v_pk_mul_f32 v[72:73], v[40:41], v[224:225]
  v_pk_mul_f32 v[74:75], v[42:43], v[226:227]
  v_pk_mul_f32 v[76:77], v[44:45], v[228:229]
  v_pk_mul_f32 v[78:79], v[46:47], v[230:231]
  v_pk_mul_f32 v[80:81], v[48:49], v[224:225]
  v_pk_mul_f32 v[82:83], v[50:51], v[226:227]
  v_pk_mul_f32 v[84:85], v[52:53], v[228:229]
  v_pk_mul_f32 v[86:87], v[54:55], v[230:231]
  v_cvt_pk_bf16_f32 v72, 0, v72
  v_cvt_pk_bf16_f32 v73, 0, v73
  v_cvt_pk_bf16_f32 v74, 0, v74
  v_cvt_pk_bf16_f32 v75, 0, v75
  v_cvt_pk_bf16_f32 v76, 0, v76
  v_cvt_pk_bf16_f32 v77, 0, v77
  v_cvt_pk_bf16_f32 v78, 0, v78
  v_cvt_pk_bf16_f32 v79, 0, v79
  v_cvt_pk_bf16_f32 v80, 0, v80
  v_cvt_pk_bf16_f32 v81, 0, v81
  v_cvt_pk_bf16_f32 v82, 0, v82
  v_cvt_pk_bf16_f32 v83, 0, v83
  v_cvt_pk_bf16_f32 v84, 0, v84
  v_cvt_pk_bf16_f32 v85, 0, v85
  v_cvt_pk_bf16_f32 v86, 0, v86
  v_cvt_pk_bf16_f32 v87, 0, v87
  v_pk_add_f32 v[240:241], v[240:241], v[72:73]
  v_pk_add_f32 v[242:243], v[242:243], v[74:75]
  v_pk_add_f32 v[244:245], v[244:245], v[76:77]
  v_pk_add_f32 v[246:247], v[246:247], v[78:79]
  v_pk_add_f32 v[248:249], v[248:249], v[80:81]
  v_pk_add_f32 v[250:251], v[250:251], v[82:83]
  v_pk_add_f32 v[252:253], v[252:253], v[84:85]
  v_pk_add_f32 v[254:255], v[254:255], v[86:87]
  v_cvt_pk_bf16_f32 v240, 0, v240
  v_cvt_pk_bf16_f32 v241, 0, v241
  v_cvt_pk_bf16_f32 v242, 0, v242
  v_cvt_pk_bf16_f32 v243, 0, v243
  v_cvt_pk_bf16_f32 v244, 0, v244
  v_cvt_pk_bf16_f32 v245, 0, v245
  v_cvt_pk_bf16_f32 v246, 0, v246
  v_cvt_pk_bf16_f32 v247, 0, v247
  v_cvt_pk_bf16_f32 v248, 0, v248
  v_cvt_pk_bf16_f32 v249, 0, v249
  v_cvt_pk_bf16_f32 v250, 0, v250
  v_cvt_pk_bf16_f32 v251, 0, v251
  v_cvt_pk_bf16_f32 v252, 0, v252
  v_cvt_pk_bf16_f32 v253, 0, v253
  buffer_store_dwordx4 v[92:95], v27, s[76:79], s13 offen sc1
  s_sub_u32 s13, s13, 1024
  v_cvt_pk_bf16_f32 v254, 0, v254
  v_cvt_pk_bf16_f32 v255, 0, v255
  v_pk_mul_f32 v[72:73], v[48:49], v[216:217]
  v_pk_mul_f32 v[74:75], v[50:51], v[218:219]
  v_pk_mul_f32 v[76:77], v[52:53], v[220:221]
  v_pk_mul_f32 v[78:79], v[54:55], v[222:223]
  v_pk_mul_f32 v[80:81], v[56:57], v[216:217]
  v_pk_mul_f32 v[82:83], v[58:59], v[218:219]
  v_pk_mul_f32 v[84:85], v[60:61], v[220:221]
  v_pk_mul_f32 v[86:87], v[62:63], v[222:223]
  v_cvt_pk_bf16_f32 v72, 0, v72
  v_cvt_pk_bf16_f32 v73, 0, v73
  v_cvt_pk_bf16_f32 v74, 0, v74
  v_cvt_pk_bf16_f32 v75, 0, v75
  v_cvt_pk_bf16_f32 v76, 0, v76
  v_cvt_pk_bf16_f32 v77, 0, v77
  v_cvt_pk_bf16_f32 v78, 0, v78
  v_cvt_pk_bf16_f32 v79, 0, v79
  v_cvt_pk_bf16_f32 v80, 0, v80
  v_cvt_pk_bf16_f32 v81, 0, v81
  v_cvt_pk_bf16_f32 v82, 0, v82
  v_cvt_pk_bf16_f32 v83, 0, v83
  v_cvt_pk_bf16_f32 v84, 0, v84
  v_cvt_pk_bf16_f32 v85, 0, v85
  v_cvt_pk_bf16_f32 v86, 0, v86
  v_cvt_pk_bf16_f32 v87, 0, v87
  v_pk_add_f32 v[240:241], v[240:241], v[72:73]
  v_pk_add_f32 v[242:243], v[242:243], v[74:75]
  v_pk_add_f32 v[244:245], v[244:245], v[76:77]
  v_pk_add_f32 v[246:247], v[246:247], v[78:79]
  v_pk_add_f32 v[248:249], v[248:249], v[80:81]
  v_pk_add_f32 v[250:251], v[250:251], v[82:83]
  v_pk_add_f32 v[252:253], v[252:253], v[84:85]
  v_pk_add_f32 v[254:255], v[254:255], v[86:87]
  v_cvt_pk_bf16_f32 v240, 0, v240
  v_cvt_pk_bf16_f32 v241, 0, v241
  v_cvt_pk_bf16_f32 v242, 0, v242
  v_cvt_pk_bf16_f32 v243, 0, v243
  v_cvt_pk_bf16_f32 v244, 0, v244
  v_cvt_pk_bf16_f32 v245, 0, v245
  v_cvt_pk_bf16_f32 v246, 0, v246
  v_cvt_pk_bf16_f32 v247, 0, v247
  v_cvt_pk_bf16_f32 v248, 0, v248
  v_cvt_pk_bf16_f32 v249, 0, v249
  v_cvt_pk_bf16_f32 v250, 0, v250
  v_cvt_pk_bf16_f32 v251, 0, v251
  v_cvt_pk_bf16_f32 v252, 0, v252
  v_cvt_pk_bf16_f32 v253, 0, v253
  v_cvt_pk_bf16_f32 v254, 0, v254
  v_cvt_pk_bf16_f32 v255, 0, v255
  v_pk_mul_f32 v[72:73], v[56:57], v[208:209]
  v_pk_mul_f32 v[74:75], v[58:59], v[210:211]
  v_pk_mul_f32 v[76:77], v[60:61], v[212:213]
  v_pk_mul_f32 v[78:79], v[62:63], v[214:215]
  v_pk_mul_f32 v[80:81], v[64:65], v[208:209]
  v_pk_mul_f32 v[82:83], v[66:67], v[210:211]
  v_pk_mul_f32 v[84:85], v[68:69], v[212:213]
  v_pk_mul_f32 v[86:87], v[70:71], v[214:215]
  v_cvt_pk_bf16_f32 v72, 0, v72
  v_cvt_pk_bf16_f32 v73, 0, v73
  v_cvt_pk_bf16_f32 v74, 0, v74
  v_cvt_pk_bf16_f32 v75, 0, v75
  v_cvt_pk_bf16_f32 v76, 0, v76
  v_cvt_pk_bf16_f32 v77, 0, v77
  v_cvt_pk_bf16_f32 v78, 0, v78
  v_cvt_pk_bf16_f32 v79, 0, v79
  v_cvt_pk_bf16_f32 v80, 0, v80
  v_cvt_pk_bf16_f32 v81, 0, v81
  v_cvt_pk_bf16_f32 v82, 0, v82
  v_cvt_pk_bf16_f32 v83, 0, v83
  v_cvt_pk_bf16_f32 v84, 0, v84
  v_cvt_pk_bf16_f32 v85, 0, v85
  v_cvt_pk_bf16_f32 v86, 0, v86
  v_cvt_pk_bf16_f32 v87, 0, v87
  v_pk_add_f32 v[240:241], v[240:241], v[72:73]
  v_pk_add_f32 v[242:243], v[242:243], v[74:75]
  v_pk_add_f32 v[244:245], v[244:245], v[76:77]
  v_pk_add_f32 v[246:247], v[246:247], v[78:79]
  v_pk_add_f32 v[248:249], v[248:249], v[80:81]
  v_pk_add_f32 v[250:251], v[250:251], v[82:83]
  v_pk_add_f32 v[252:253], v[252:253], v[84:85]
  v_pk_add_f32 v[254:255], v[254:255], v[86:87]
  v_cvt_pk_bf16_f32 v240, 0, v240
  v_cvt_pk_bf16_f32 v241, 0, v241
  v_cvt_pk_bf16_f32 v242, 0, v242
  v_cvt_pk_bf16_f32 v243, 0, v243
  v_cvt_pk_bf16_f32 v244, 0, v244
  v_cvt_pk_bf16_f32 v245, 0, v245
  v_cvt_pk_bf16_f32 v246, 0, v246
  v_cvt_pk_bf16_f32 v247, 0, v247
  v_cvt_pk_bf16_f32 v248, 0, v248
  v_cvt_pk_bf16_f32 v249, 0, v249
  v_cvt_pk_bf16_f32 v250, 0, v250
  v_cvt_pk_bf16_f32 v251, 0, v251
  v_cvt_pk_bf16_f32 v252, 0, v252
  v_cvt_pk_bf16_f32 v253, 0, v253
  v_cvt_pk_bf16_f32 v254, 0, v254
  v_cvt_pk_bf16_f32 v255, 0, v255
  v_lshlrev_b32 v72, 16, v144
  v_and_b32 v73, 0xffff0000, v144
  v_lshlrev_b32 v74, 16, v145
  v_and_b32 v75, 0xffff0000, v145
  v_lshlrev_b32 v76, 16, v146
  v_and_b32 v77, 0xffff0000, v146
  v_lshlrev_b32 v78, 16, v147
  v_and_b32 v79, 0xffff0000, v147
  v_lshlrev_b32 v80, 16, v148
  v_and_b32 v81, 0xffff0000, v148
  v_lshlrev_b32 v82, 16, v149
  v_and_b32 v83, 0xffff0000, v149
  v_lshlrev_b32 v84, 16, v150
  v_and_b32 v85, 0xffff0000, v150
  v_lshlrev_b32 v86, 16, v151
  v_and_b32 v87, 0xffff0000, v151
  v_pk_mul_f32 v[240:241], v[240:241], v[72:73]
  v_pk_mul_f32 v[242:243], v[242:243], v[74:75]
  v_pk_mul_f32 v[244:245], v[244:245], v[76:77]
  v_pk_mul_f32 v[246:247], v[246:247], v[78:79]
  v_pk_mul_f32 v[248:249], v[248:249], v[80:81]
  v_pk_mul_f32 v[250:251], v[250:251], v[82:83]
  v_pk_mul_f32 v[252:253], v[252:253], v[84:85]
  v_pk_mul_f32 v[254:255], v[254:255], v[86:87]
  v_cvt_pk_bf16_f32 v124, v240, v241
  v_cvt_pk_bf16_f32 v125, v242, v243
  v_cvt_pk_bf16_f32 v126, v244, v245
  v_cvt_pk_bf16_f32 v127, v246, v247
  v_cvt_pk_bf16_f32 v128, v248, v249
  v_cvt_pk_bf16_f32 v129, v250, v251
  v_cvt_pk_bf16_f32 v130, v252, v253
  v_cvt_pk_bf16_f32 v131, v254, v255
  ds_write_b128 v22, v[124:127] offset:9216
  ds_write_b128 v22, v[128:131] offset:9360
  s_waitcnt lgkmcnt(0)
  s_barrier
  ds_read_b64_tr_b16 v[88:89], v23 offset:9792
  ds_read_b64_tr_b16 v[90:91], v23 offset:9216
  ds_read_b64_tr_b16 v[92:93], v23 offset:9808
  ds_read_b64_tr_b16 v[94:95], v23 offset:9232
  s_waitcnt vmcnt(10)
  v_lshlrev_b32 v32, 16, v152
  v_and_b32 v33, 0xffff0000, v152
  v_lshlrev_b32 v34, 16, v153
  v_and_b32 v35, 0xffff0000, v153
  v_lshlrev_b32 v36, 16, v154
  v_and_b32 v37, 0xffff0000, v154
  v_lshlrev_b32 v38, 16, v155
  v_and_b32 v39, 0xffff0000, v155
  v_lshlrev_b32 v40, 16, v156
  v_and_b32 v41, 0xffff0000, v156
  v_lshlrev_b32 v42, 16, v157
  v_and_b32 v43, 0xffff0000, v157
  v_lshlrev_b32 v44, 16, v158
  v_and_b32 v45, 0xffff0000, v158
  v_lshlrev_b32 v46, 16, v159
  v_and_b32 v47, 0xffff0000, v159
  v_lshlrev_b32 v48, 16, v160
  v_and_b32 v49, 0xffff0000, v160
  v_lshlrev_b32 v50, 16, v161
  v_and_b32 v51, 0xffff0000, v161
  v_lshlrev_b32 v52, 16, v162
  v_and_b32 v53, 0xffff0000, v162
  v_lshlrev_b32 v54, 16, v163
  v_and_b32 v55, 0xffff0000, v163
  s_waitcnt lgkmcnt(0)
  buffer_store_dwordx4 v[88:91], v24, s[76:79], s13 offen sc1
  v_lshlrev_b32 v56, 16, v164
  v_and_b32 v57, 0xffff0000, v164
  v_lshlrev_b32 v58, 16, v165
  v_and_b32 v59, 0xffff0000, v165
  v_lshlrev_b32 v60, 16, v166
  v_and_b32 v61, 0xffff0000, v166
  v_lshlrev_b32 v62, 16, v167
  v_and_b32 v63, 0xffff0000, v167
  v_lshlrev_b32 v64, 16, v168
  v_and_b32 v65, 0xffff0000, v168
  v_lshlrev_b32 v66, 16, v169
  v_and_b32 v67, 0xffff0000, v169
  v_lshlrev_b32 v68, 16, v170
  v_and_b32 v69, 0xffff0000, v170
  v_lshlrev_b32 v70, 16, v171
  v_and_b32 v71, 0xffff0000, v171
  v_pk_mul_f32 v[240:241], v[32:33], v[232:233]
  v_pk_mul_f32 v[242:243], v[34:35], v[234:235]
  v_pk_mul_f32 v[244:245], v[36:37], v[236:237]
  v_pk_mul_f32 v[246:247], v[38:39], v[238:239]
  v_pk_mul_f32 v[248:249], v[40:41], v[232:233]
  v_pk_mul_f32 v[250:251], v[42:43], v[234:235]
  v_pk_mul_f32 v[252:253], v[44:45], v[236:237]
  v_pk_mul_f32 v[254:255], v[46:47], v[238:239]
  v_cvt_pk_bf16_f32 v240, 0, v240
  v_cvt_pk_bf16_f32 v241, 0, v241
  v_cvt_pk_bf16_f32 v242, 0, v242
  v_cvt_pk_bf16_f32 v243, 0, v243
  v_cvt_pk_bf16_f32 v244, 0, v244
  v_cvt_pk_bf16_f32 v245, 0, v245
  v_cvt_pk_bf16_f32 v246, 0, v246
  v_cvt_pk_bf16_f32 v247, 0, v247
  v_cvt_pk_bf16_f32 v248, 0, v248
  v_cvt_pk_bf16_f32 v249, 0, v249
  v_cvt_pk_bf16_f32 v250, 0, v250
  v_cvt_pk_bf16_f32 v251, 0, v251
  v_cvt_pk_bf16_f32 v252, 0, v252
  v_cvt_pk_bf16_f32 v253, 0, v253
  v_cvt_pk_bf16_f32 v254, 0, v254
  v_cvt_pk_bf16_f32 v255, 0, v255
  v_pk_mul_f32 v[72:73], v[40:41], v[224:225]
  v_pk_mul_f32 v[74:75], v[42:43], v[226:227]
  v_pk_mul_f32 v[76:77], v[44:45], v[228:229]
  v_pk_mul_f32 v[78:79], v[46:47], v[230:231]
  v_pk_mul_f32 v[80:81], v[48:49], v[224:225]
  v_pk_mul_f32 v[82:83], v[50:51], v[226:227]
  v_pk_mul_f32 v[84:85], v[52:53], v[228:229]
  v_pk_mul_f32 v[86:87], v[54:55], v[230:231]
  v_cvt_pk_bf16_f32 v72, 0, v72
  v_cvt_pk_bf16_f32 v73, 0, v73
  v_cvt_pk_bf16_f32 v74, 0, v74
  v_cvt_pk_bf16_f32 v75, 0, v75
  v_cvt_pk_bf16_f32 v76, 0, v76
  v_cvt_pk_bf16_f32 v77, 0, v77
  v_cvt_pk_bf16_f32 v78, 0, v78
  v_cvt_pk_bf16_f32 v79, 0, v79
  v_cvt_pk_bf16_f32 v80, 0, v80
  v_cvt_pk_bf16_f32 v81, 0, v81
  v_cvt_pk_bf16_f32 v82, 0, v82
  v_cvt_pk_bf16_f32 v83, 0, v83
  v_cvt_pk_bf16_f32 v84, 0, v84
  v_cvt_pk_bf16_f32 v85, 0, v85
  v_cvt_pk_bf16_f32 v86, 0, v86
  v_cvt_pk_bf16_f32 v87, 0, v87
  v_pk_add_f32 v[240:241], v[240:241], v[72:73]
  v_pk_add_f32 v[242:243], v[242:243], v[74:75]
  v_pk_add_f32 v[244:245], v[244:245], v[76:77]
  v_pk_add_f32 v[246:247], v[246:247], v[78:79]
  v_pk_add_f32 v[248:249], v[248:249], v[80:81]
  v_pk_add_f32 v[250:251], v[250:251], v[82:83]
  v_pk_add_f32 v[252:253], v[252:253], v[84:85]
  v_pk_add_f32 v[254:255], v[254:255], v[86:87]
  v_cvt_pk_bf16_f32 v240, 0, v240
  v_cvt_pk_bf16_f32 v241, 0, v241
  v_cvt_pk_bf16_f32 v242, 0, v242
  v_cvt_pk_bf16_f32 v243, 0, v243
  v_cvt_pk_bf16_f32 v244, 0, v244
  v_cvt_pk_bf16_f32 v245, 0, v245
  v_cvt_pk_bf16_f32 v246, 0, v246
  v_cvt_pk_bf16_f32 v247, 0, v247
  v_cvt_pk_bf16_f32 v248, 0, v248
  v_cvt_pk_bf16_f32 v249, 0, v249
  v_cvt_pk_bf16_f32 v250, 0, v250
  v_cvt_pk_bf16_f32 v251, 0, v251
  v_cvt_pk_bf16_f32 v252, 0, v252
  v_cvt_pk_bf16_f32 v253, 0, v253
  buffer_store_dwordx4 v[92:95], v27, s[76:79], s13 offen sc1
  s_sub_u32 s13, s13, 1024
  v_cvt_pk_bf16_f32 v254, 0, v254
  v_cvt_pk_bf16_f32 v255, 0, v255
  v_pk_mul_f32 v[72:73], v[48:49], v[216:217]
  v_pk_mul_f32 v[74:75], v[50:51], v[218:219]
  v_pk_mul_f32 v[76:77], v[52:53], v[220:221]
  v_pk_mul_f32 v[78:79], v[54:55], v[222:223]
  v_pk_mul_f32 v[80:81], v[56:57], v[216:217]
  v_pk_mul_f32 v[82:83], v[58:59], v[218:219]
  v_pk_mul_f32 v[84:85], v[60:61], v[220:221]
  v_pk_mul_f32 v[86:87], v[62:63], v[222:223]
  v_cvt_pk_bf16_f32 v72, 0, v72
  v_cvt_pk_bf16_f32 v73, 0, v73
  v_cvt_pk_bf16_f32 v74, 0, v74
  v_cvt_pk_bf16_f32 v75, 0, v75
  v_cvt_pk_bf16_f32 v76, 0, v76
  v_cvt_pk_bf16_f32 v77, 0, v77
  v_cvt_pk_bf16_f32 v78, 0, v78
  v_cvt_pk_bf16_f32 v79, 0, v79
  v_cvt_pk_bf16_f32 v80, 0, v80
  v_cvt_pk_bf16_f32 v81, 0, v81
  v_cvt_pk_bf16_f32 v82, 0, v82
  v_cvt_pk_bf16_f32 v83, 0, v83
  v_cvt_pk_bf16_f32 v84, 0, v84
  v_cvt_pk_bf16_f32 v85, 0, v85
  v_cvt_pk_bf16_f32 v86, 0, v86
  v_cvt_pk_bf16_f32 v87, 0, v87
  v_pk_add_f32 v[240:241], v[240:241], v[72:73]
  v_pk_add_f32 v[242:243], v[242:243], v[74:75]
  v_pk_add_f32 v[244:245], v[244:245], v[76:77]
  v_pk_add_f32 v[246:247], v[246:247], v[78:79]
  v_pk_add_f32 v[248:249], v[248:249], v[80:81]
  v_pk_add_f32 v[250:251], v[250:251], v[82:83]
  v_pk_add_f32 v[252:253], v[252:253], v[84:85]
  v_pk_add_f32 v[254:255], v[254:255], v[86:87]
  v_cvt_pk_bf16_f32 v240, 0, v240
  v_cvt_pk_bf16_f32 v241, 0, v241
  v_cvt_pk_bf16_f32 v242, 0, v242
  v_cvt_pk_bf16_f32 v243, 0, v243
  v_cvt_pk_bf16_f32 v244, 0, v244
  v_cvt_pk_bf16_f32 v245, 0, v245
  v_cvt_pk_bf16_f32 v246, 0, v246
  v_cvt_pk_bf16_f32 v247, 0, v247
  v_cvt_pk_bf16_f32 v248, 0, v248
  v_cvt_pk_bf16_f32 v249, 0, v249
  v_cvt_pk_bf16_f32 v250, 0, v250
  v_cvt_pk_bf16_f32 v251, 0, v251
  v_cvt_pk_bf16_f32 v252, 0, v252
  v_cvt_pk_bf16_f32 v253, 0, v253
  v_cvt_pk_bf16_f32 v254, 0, v254
  v_cvt_pk_bf16_f32 v255, 0, v255
  v_pk_mul_f32 v[72:73], v[56:57], v[208:209]
  v_pk_mul_f32 v[74:75], v[58:59], v[210:211]
  v_pk_mul_f32 v[76:77], v[60:61], v[212:213]
  v_pk_mul_f32 v[78:79], v[62:63], v[214:215]
  v_pk_mul_f32 v[80:81], v[64:65], v[208:209]
  v_pk_mul_f32 v[82:83], v[66:67], v[210:211]
  v_pk_mul_f32 v[84:85], v[68:69], v[212:213]
  v_pk_mul_f32 v[86:87], v[70:71], v[214:215]
  v_cvt_pk_bf16_f32 v72, 0, v72
  v_cvt_pk_bf16_f32 v73, 0, v73
  v_cvt_pk_bf16_f32 v74, 0, v74
  v_cvt_pk_bf16_f32 v75, 0, v75
  v_cvt_pk_bf16_f32 v76, 0, v76
  v_cvt_pk_bf16_f32 v77, 0, v77
  v_cvt_pk_bf16_f32 v78, 0, v78
  v_cvt_pk_bf16_f32 v79, 0, v79
  v_cvt_pk_bf16_f32 v80, 0, v80
  v_cvt_pk_bf16_f32 v81, 0, v81
  v_cvt_pk_bf16_f32 v82, 0, v82
  v_cvt_pk_bf16_f32 v83, 0, v83
  v_cvt_pk_bf16_f32 v84, 0, v84
  v_cvt_pk_bf16_f32 v85, 0, v85
  v_cvt_pk_bf16_f32 v86, 0, v86
  v_cvt_pk_bf16_f32 v87, 0, v87
  v_pk_add_f32 v[240:241], v[240:241], v[72:73]
  v_pk_add_f32 v[242:243], v[242:243], v[74:75]
  v_pk_add_f32 v[244:245], v[244:245], v[76:77]
  v_pk_add_f32 v[246:247], v[246:247], v[78:79]
  v_pk_add_f32 v[248:249], v[248:249], v[80:81]
  v_pk_add_f32 v[250:251], v[250:251], v[82:83]
  v_pk_add_f32 v[252:253], v[252:253], v[84:85]
  v_pk_add_f32 v[254:255], v[254:255], v[86:87]
  v_cvt_pk_bf16_f32 v240, 0, v240
  v_cvt_pk_bf16_f32 v241, 0, v241
  v_cvt_pk_bf16_f32 v242, 0, v242
  v_cvt_pk_bf16_f32 v243, 0, v243
  v_cvt_pk_bf16_f32 v244, 0, v244
  v_cvt_pk_bf16_f32 v245, 0, v245
  v_cvt_pk_bf16_f32 v246, 0, v246
  v_cvt_pk_bf16_f32 v247, 0, v247
  v_cvt_pk_bf16_f32 v248, 0, v248
  v_cvt_pk_bf16_f32 v249, 0, v249
  v_cvt_pk_bf16_f32 v250, 0, v250
  v_cvt_pk_bf16_f32 v251, 0, v251
  v_cvt_pk_bf16_f32 v252, 0, v252
  v_cvt_pk_bf16_f32 v253, 0, v253
  v_cvt_pk_bf16_f32 v254, 0, v254
  v_cvt_pk_bf16_f32 v255, 0, v255
  v_lshlrev_b32 v72, 16, v172
  v_and_b32 v73, 0xffff0000, v172
  v_lshlrev_b32 v74, 16, v173
  v_and_b32 v75, 0xffff0000, v173
  v_lshlrev_b32 v76, 16, v174
  v_and_b32 v77, 0xffff0000, v174
  v_lshlrev_b32 v78, 16, v175
  v_and_b32 v79, 0xffff0000, v175
  v_lshlrev_b32 v80, 16, v176
  v_and_b32 v81, 0xffff0000, v176
  v_lshlrev_b32 v82, 16, v177
  v_and_b32 v83, 0xffff0000, v177
  v_lshlrev_b32 v84, 16, v178
  v_and_b32 v85, 0xffff0000, v178
  v_lshlrev_b32 v86, 16, v179
  v_and_b32 v87, 0xffff0000, v179
  v_pk_mul_f32 v[240:241], v[240:241], v[72:73]
  v_pk_mul_f32 v[242:243], v[242:243], v[74:75]
  v_pk_mul_f32 v[244:245], v[244:245], v[76:77]
  v_pk_mul_f32 v[246:247], v[246:247], v[78:79]
  v_pk_mul_f32 v[248:249], v[248:249], v[80:81]
  v_pk_mul_f32 v[250:251], v[250:251], v[82:83]
  v_pk_mul_f32 v[252:253], v[252:253], v[84:85]
  v_pk_mul_f32 v[254:255], v[254:255], v[86:87]
  v_cvt_pk_bf16_f32 v152, v240, v241
  v_cvt_pk_bf16_f32 v153, v242, v243
  v_cvt_pk_bf16_f32 v154, v244, v245
  v_cvt_pk_bf16_f32 v155, v246, v247
  v_cvt_pk_bf16_f32 v156, v248, v249
  v_cvt_pk_bf16_f32 v157, v250, v251
  v_cvt_pk_bf16_f32 v158, v252, v253
  v_cvt_pk_bf16_f32 v159, v254, v255
  ds_write_b128 v22, v[152:155] offset:18432
  ds_write_b128 v22, v[156:159] offset:18576
  s_waitcnt lgkmcnt(0)
  s_barrier
  ds_read_b64_tr_b16 v[88:89], v23 offset:19008
  ds_read_b64_tr_b16 v[90:91], v23 offset:18432
  ds_read_b64_tr_b16 v[92:93], v23 offset:19024
  ds_read_b64_tr_b16 v[94:95], v23 offset:18448
  s_waitcnt vmcnt(5)
  v_lshlrev_b32 v32, 16, v180
  v_and_b32 v33, 0xffff0000, v180
  v_lshlrev_b32 v34, 16, v181
  v_and_b32 v35, 0xffff0000, v181
  v_lshlrev_b32 v36, 16, v182
  v_and_b32 v37, 0xffff0000, v182
  v_lshlrev_b32 v38, 16, v183
  v_and_b32 v39, 0xffff0000, v183
  v_lshlrev_b32 v40, 16, v184
  v_and_b32 v41, 0xffff0000, v184
  v_lshlrev_b32 v42, 16, v185
  v_and_b32 v43, 0xffff0000, v185
  v_lshlrev_b32 v44, 16, v186
  v_and_b32 v45, 0xffff0000, v186
  v_lshlrev_b32 v46, 16, v187
  v_and_b32 v47, 0xffff0000, v187
  v_lshlrev_b32 v48, 16, v188
  v_and_b32 v49, 0xffff0000, v188
  v_lshlrev_b32 v50, 16, v189
  v_and_b32 v51, 0xffff0000, v189
  v_lshlrev_b32 v52, 16, v190
  v_and_b32 v53, 0xffff0000, v190
  v_lshlrev_b32 v54, 16, v191
  v_and_b32 v55, 0xffff0000, v191
  s_waitcnt lgkmcnt(0)
  buffer_store_dwordx4 v[88:91], v24, s[76:79], s13 offen sc1
  v_lshlrev_b32 v56, 16, v192
  v_and_b32 v57, 0xffff0000, v192
  v_lshlrev_b32 v58, 16, v193
  v_and_b32 v59, 0xffff0000, v193
  v_lshlrev_b32 v60, 16, v194
  v_and_b32 v61, 0xffff0000, v194
  v_lshlrev_b32 v62, 16, v195
  v_and_b32 v63, 0xffff0000, v195
  v_lshlrev_b32 v64, 16, v196
  v_and_b32 v65, 0xffff0000, v196
  v_lshlrev_b32 v66, 16, v197
  v_and_b32 v67, 0xffff0000, v197
  v_lshlrev_b32 v68, 16, v198
  v_and_b32 v69, 0xffff0000, v198
  v_lshlrev_b32 v70, 16, v199
  v_and_b32 v71, 0xffff0000, v199
  v_pk_mul_f32 v[240:241], v[32:33], v[232:233]
  v_pk_mul_f32 v[242:243], v[34:35], v[234:235]
  v_pk_mul_f32 v[244:245], v[36:37], v[236:237]
  v_pk_mul_f32 v[246:247], v[38:39], v[238:239]
  v_pk_mul_f32 v[248:249], v[40:41], v[232:233]
  v_pk_mul_f32 v[250:251], v[42:43], v[234:235]
  v_pk_mul_f32 v[252:253], v[44:45], v[236:237]
  v_pk_mul_f32 v[254:255], v[46:47], v[238:239]
  v_cvt_pk_bf16_f32 v240, 0, v240
  v_cvt_pk_bf16_f32 v241, 0, v241
  v_cvt_pk_bf16_f32 v242, 0, v242
  v_cvt_pk_bf16_f32 v243, 0, v243
  v_cvt_pk_bf16_f32 v244, 0, v244
  v_cvt_pk_bf16_f32 v245, 0, v245
  v_cvt_pk_bf16_f32 v246, 0, v246
  v_cvt_pk_bf16_f32 v247, 0, v247
  v_cvt_pk_bf16_f32 v248, 0, v248
  v_cvt_pk_bf16_f32 v249, 0, v249
  v_cvt_pk_bf16_f32 v250, 0, v250
  v_cvt_pk_bf16_f32 v251, 0, v251
  v_cvt_pk_bf16_f32 v252, 0, v252
  v_cvt_pk_bf16_f32 v253, 0, v253
  v_cvt_pk_bf16_f32 v254, 0, v254
  v_cvt_pk_bf16_f32 v255, 0, v255
  v_pk_mul_f32 v[72:73], v[40:41], v[224:225]
  v_pk_mul_f32 v[74:75], v[42:43], v[226:227]
  v_pk_mul_f32 v[76:77], v[44:45], v[228:229]
  v_pk_mul_f32 v[78:79], v[46:47], v[230:231]
  v_pk_mul_f32 v[80:81], v[48:49], v[224:225]
  v_pk_mul_f32 v[82:83], v[50:51], v[226:227]
  v_pk_mul_f32 v[84:85], v[52:53], v[228:229]
  v_pk_mul_f32 v[86:87], v[54:55], v[230:231]
  v_cvt_pk_bf16_f32 v72, 0, v72
  v_cvt_pk_bf16_f32 v73, 0, v73
  v_cvt_pk_bf16_f32 v74, 0, v74
  v_cvt_pk_bf16_f32 v75, 0, v75
  v_cvt_pk_bf16_f32 v76, 0, v76
  v_cvt_pk_bf16_f32 v77, 0, v77
  v_cvt_pk_bf16_f32 v78, 0, v78
  v_cvt_pk_bf16_f32 v79, 0, v79
  v_cvt_pk_bf16_f32 v80, 0, v80
  v_cvt_pk_bf16_f32 v81, 0, v81
  v_cvt_pk_bf16_f32 v82, 0, v82
  v_cvt_pk_bf16_f32 v83, 0, v83
  v_cvt_pk_bf16_f32 v84, 0, v84
  v_cvt_pk_bf16_f32 v85, 0, v85
  v_cvt_pk_bf16_f32 v86, 0, v86
  v_cvt_pk_bf16_f32 v87, 0, v87
  v_pk_add_f32 v[240:241], v[240:241], v[72:73]
  v_pk_add_f32 v[242:243], v[242:243], v[74:75]
  v_pk_add_f32 v[244:245], v[244:245], v[76:77]
  v_pk_add_f32 v[246:247], v[246:247], v[78:79]
  v_pk_add_f32 v[248:249], v[248:249], v[80:81]
  v_pk_add_f32 v[250:251], v[250:251], v[82:83]
  v_pk_add_f32 v[252:253], v[252:253], v[84:85]
  v_pk_add_f32 v[254:255], v[254:255], v[86:87]
  v_cvt_pk_bf16_f32 v240, 0, v240
  v_cvt_pk_bf16_f32 v241, 0, v241
  v_cvt_pk_bf16_f32 v242, 0, v242
  v_cvt_pk_bf16_f32 v243, 0, v243
  v_cvt_pk_bf16_f32 v244, 0, v244
  v_cvt_pk_bf16_f32 v245, 0, v245
  v_cvt_pk_bf16_f32 v246, 0, v246
  v_cvt_pk_bf16_f32 v247, 0, v247
  v_cvt_pk_bf16_f32 v248, 0, v248
  v_cvt_pk_bf16_f32 v249, 0, v249
  v_cvt_pk_bf16_f32 v250, 0, v250
  v_cvt_pk_bf16_f32 v251, 0, v251
  v_cvt_pk_bf16_f32 v252, 0, v252
  v_cvt_pk_bf16_f32 v253, 0, v253
  buffer_store_dwordx4 v[92:95], v27, s[76:79], s13 offen sc1
  s_sub_u32 s13, s13, 1024
  v_cvt_pk_bf16_f32 v254, 0, v254
  v_cvt_pk_bf16_f32 v255, 0, v255
  v_pk_mul_f32 v[72:73], v[48:49], v[216:217]
  v_pk_mul_f32 v[74:75], v[50:51], v[218:219]
  v_pk_mul_f32 v[76:77], v[52:53], v[220:221]
  v_pk_mul_f32 v[78:79], v[54:55], v[222:223]
  v_pk_mul_f32 v[80:81], v[56:57], v[216:217]
  v_pk_mul_f32 v[82:83], v[58:59], v[218:219]
  v_pk_mul_f32 v[84:85], v[60:61], v[220:221]
  v_pk_mul_f32 v[86:87], v[62:63], v[222:223]
  v_cvt_pk_bf16_f32 v72, 0, v72
  v_cvt_pk_bf16_f32 v73, 0, v73
  v_cvt_pk_bf16_f32 v74, 0, v74
  v_cvt_pk_bf16_f32 v75, 0, v75
  v_cvt_pk_bf16_f32 v76, 0, v76
  v_cvt_pk_bf16_f32 v77, 0, v77
  v_cvt_pk_bf16_f32 v78, 0, v78
  v_cvt_pk_bf16_f32 v79, 0, v79
  v_cvt_pk_bf16_f32 v80, 0, v80
  v_cvt_pk_bf16_f32 v81, 0, v81
  v_cvt_pk_bf16_f32 v82, 0, v82
  v_cvt_pk_bf16_f32 v83, 0, v83
  v_cvt_pk_bf16_f32 v84, 0, v84
  v_cvt_pk_bf16_f32 v85, 0, v85
  v_cvt_pk_bf16_f32 v86, 0, v86
  v_cvt_pk_bf16_f32 v87, 0, v87
  v_pk_add_f32 v[240:241], v[240:241], v[72:73]
  v_pk_add_f32 v[242:243], v[242:243], v[74:75]
  v_pk_add_f32 v[244:245], v[244:245], v[76:77]
  v_pk_add_f32 v[246:247], v[246:247], v[78:79]
  v_pk_add_f32 v[248:249], v[248:249], v[80:81]
  v_pk_add_f32 v[250:251], v[250:251], v[82:83]
  v_pk_add_f32 v[252:253], v[252:253], v[84:85]
  v_pk_add_f32 v[254:255], v[254:255], v[86:87]
  v_cvt_pk_bf16_f32 v240, 0, v240
  v_cvt_pk_bf16_f32 v241, 0, v241
  v_cvt_pk_bf16_f32 v242, 0, v242
  v_cvt_pk_bf16_f32 v243, 0, v243
  v_cvt_pk_bf16_f32 v244, 0, v244
  v_cvt_pk_bf16_f32 v245, 0, v245
  v_cvt_pk_bf16_f32 v246, 0, v246
  v_cvt_pk_bf16_f32 v247, 0, v247
  v_cvt_pk_bf16_f32 v248, 0, v248
  v_cvt_pk_bf16_f32 v249, 0, v249
  v_cvt_pk_bf16_f32 v250, 0, v250
  v_cvt_pk_bf16_f32 v251, 0, v251
  v_cvt_pk_bf16_f32 v252, 0, v252
  v_cvt_pk_bf16_f32 v253, 0, v253
  v_cvt_pk_bf16_f32 v254, 0, v254
  v_cvt_pk_bf16_f32 v255, 0, v255
  v_pk_mul_f32 v[72:73], v[56:57], v[208:209]
  v_pk_mul_f32 v[74:75], v[58:59], v[210:211]
  v_pk_mul_f32 v[76:77], v[60:61], v[212:213]
  v_pk_mul_f32 v[78:79], v[62:63], v[214:215]
  v_pk_mul_f32 v[80:81], v[64:65], v[208:209]
  v_pk_mul_f32 v[82:83], v[66:67], v[210:211]
  v_pk_mul_f32 v[84:85], v[68:69], v[212:213]
  v_pk_mul_f32 v[86:87], v[70:71], v[214:215]
  v_cvt_pk_bf16_f32 v72, 0, v72
  v_cvt_pk_bf16_f32 v73, 0, v73
  v_cvt_pk_bf16_f32 v74, 0, v74
  v_cvt_pk_bf16_f32 v75, 0, v75
  v_cvt_pk_bf16_f32 v76, 0, v76
  v_cvt_pk_bf16_f32 v77, 0, v77
  v_cvt_pk_bf16_f32 v78, 0, v78
  v_cvt_pk_bf16_f32 v79, 0, v79
  v_cvt_pk_bf16_f32 v80, 0, v80
  v_cvt_pk_bf16_f32 v81, 0, v81
  v_cvt_pk_bf16_f32 v82, 0, v82
  v_cvt_pk_bf16_f32 v83, 0, v83
  v_cvt_pk_bf16_f32 v84, 0, v84
  v_cvt_pk_bf16_f32 v85, 0, v85
  v_cvt_pk_bf16_f32 v86, 0, v86
  v_cvt_pk_bf16_f32 v87, 0, v87
  v_pk_add_f32 v[240:241], v[240:241], v[72:73]
  v_pk_add_f32 v[242:243], v[242:243], v[74:75]
  v_pk_add_f32 v[244:245], v[244:245], v[76:77]
  v_pk_add_f32 v[246:247], v[246:247], v[78:79]
  v_pk_add_f32 v[248:249], v[248:249], v[80:81]
  v_pk_add_f32 v[250:251], v[250:251], v[82:83]
  v_pk_add_f32 v[252:253], v[252:253], v[84:85]
  v_pk_add_f32 v[254:255], v[254:255], v[86:87]
  v_cvt_pk_bf16_f32 v240, 0, v240
  v_cvt_pk_bf16_f32 v241, 0, v241
  v_cvt_pk_bf16_f32 v242, 0, v242
  v_cvt_pk_bf16_f32 v243, 0, v243
  v_cvt_pk_bf16_f32 v244, 0, v244
  v_cvt_pk_bf16_f32 v245, 0, v245
  v_cvt_pk_bf16_f32 v246, 0, v246
  v_cvt_pk_bf16_f32 v247, 0, v247
  v_cvt_pk_bf16_f32 v248, 0, v248
  v_cvt_pk_bf16_f32 v249, 0, v249
  v_cvt_pk_bf16_f32 v250, 0, v250
  v_cvt_pk_bf16_f32 v251, 0, v251
  v_cvt_pk_bf16_f32 v252, 0, v252
  v_cvt_pk_bf16_f32 v253, 0, v253
  v_cvt_pk_bf16_f32 v254, 0, v254
  v_cvt_pk_bf16_f32 v255, 0, v255
  v_lshlrev_b32 v72, 16, v200
  v_and_b32 v73, 0xffff0000, v200
  v_lshlrev_b32 v74, 16, v201
  v_and_b32 v75, 0xffff0000, v201
  v_lshlrev_b32 v76, 16, v202
  v_and_b32 v77, 0xffff0000, v202
  v_lshlrev_b32 v78, 16, v203
  v_and_b32 v79, 0xffff0000, v203
  v_lshlrev_b32 v80, 16, v204
  v_and_b32 v81, 0xffff0000, v204
  v_lshlrev_b32 v82, 16, v205
  v_and_b32 v83, 0xffff0000, v205
  v_lshlrev_b32 v84, 16, v206
  v_and_b32 v85, 0xffff0000, v206
  v_lshlrev_b32 v86, 16, v207
  v_and_b32 v87, 0xffff0000, v207
  v_pk_mul_f32 v[240:241], v[240:241], v[72:73]
  v_pk_mul_f32 v[242:243], v[242:243], v[74:75]
  v_pk_mul_f32 v[244:245], v[244:245], v[76:77]
  v_pk_mul_f32 v[246:247], v[246:247], v[78:79]
  v_pk_mul_f32 v[248:249], v[248:249], v[80:81]
  v_pk_mul_f32 v[250:251], v[250:251], v[82:83]
  v_pk_mul_f32 v[252:253], v[252:253], v[84:85]
  v_pk_mul_f32 v[254:255], v[254:255], v[86:87]
  v_cvt_pk_bf16_f32 v180, v240, v241
  v_cvt_pk_bf16_f32 v181, v242, v243
  v_cvt_pk_bf16_f32 v182, v244, v245
  v_cvt_pk_bf16_f32 v183, v246, v247
  v_cvt_pk_bf16_f32 v184, v248, v249
  v_cvt_pk_bf16_f32 v185, v250, v251
  v_cvt_pk_bf16_f32 v186, v252, v253
  v_cvt_pk_bf16_f32 v187, v254, v255
  ds_write_b128 v22, v[180:183] offset:27648
  ds_write_b128 v22, v[184:187] offset:27792
  s_waitcnt lgkmcnt(0)
  s_barrier
  ds_read_b64_tr_b16 v[88:89], v23 offset:28224
  ds_read_b64_tr_b16 v[90:91], v23 offset:27648
  ds_read_b64_tr_b16 v[92:93], v23 offset:28240
  ds_read_b64_tr_b16 v[94:95], v23 offset:27664
  s_waitcnt lgkmcnt(0)
  buffer_store_dwordx4 v[88:91], v24, s[76:79], s13 offen sc1
  buffer_store_dwordx4 v[92:95], v27, s[76:79], s13 offen sc1
  s_sub_u32 s13, s13, 1024
  s_lshl_b32 s8, s14, 7
  s_add_u32 s8, s8, 8519680
  s_cmp_eq_u32 s80, 0
  s_cselect_b32 s8, s8, 1073741824
  v_mov_b32 v30, s85
  v_lshlrev_b32 v31, 10, v1
  s_waitcnt vmcnt(0)
  s_barrier
  s_mov_b64 exec, 15
  buffer_store_dword v30, v31, s[76:79], s8 offen sc1
  s_mov_b64 exec, -1
  s_branch L9
L8:
  s_waitcnt vmcnt(0)
  s_mov_b32 s8, s2
  s_mul_i32 s8, s8, 16
  s_add_u32 s8, s8, 8454144
  s_cmp_eq_u32 s80, 0
  s_cselect_b32 s8, s8, 1073741824
  v_mov_b32 v30, s85
  v_mov_b32 v31, 0
  s_barrier
  s_mov_b64 exec, 1
  buffer_store_dword v30, v31, s[76:79], s8 offen sc1
  s_mov_b64 exec, -1
L9:
  s_cmp_eq_u32 s87, 0
  s_cbranch_scc1 ROLEC
  s_lshl_b32 s15, s83, 5
  s_add_u32 s15, s15, s84
  s_lshl_b32 s13, s15, 2
  s_lshl_b32 s15, s15, 13
  s_lshl_b32 s14, s80, 11
  s_add_u32 s14, s14, s15
  s_lshr_b32 s9, s80, 1
  s_mul_i32 s12, s9, 12544
  s_lshl_b32 s9, s9, 1
  s_add_u32 s13, s13, s9
  s_lshl_b32 s9, s80, 11
  s_add_u32 s12, s12, s9
  s_add_u32 s12, s12, 32
  v_add_u32 v3, s12, v2
  v_bfe_u32 v19, v1, 2, 1
  v_lshlrev_b32 v19, 12, v19
  v_mov_b32 v22, 0
  buffer_load_dwordx4 v[176:179], v2, s[48:51], s14 offen offset:0
  buffer_load_dwordx2 v[180:181], v2, s[48:51], s14 offen offset:16
  buffer_load_dwordx4 v[182:185], v2, s[48:51], s14 offen offset:1024
  buffer_load_dwordx2 v[186:187], v2, s[48:51], s14 offen offset:1040
  buffer_load_dwordx2 v[20:21], v19, s[48:51], s15 offen
  buffer_load_ushort v11, v22, s[52:55], s13 offen
  v_and_b32 v16, 15, v1
  v_lshrrev_b32 v17, 4, v1
  v_add_u32 v18, 1, v16
  v_and_b32 v166, 3, v18
  v_mul_u32_u24 v166, 4160, v166
  v_and_b32 v18, 28, v18
  v_lshl_add_u32 v18, v17, 3, v18
  v_lshl_add_u32 v166, v18, 1, v166
  s_lshr_b32 s14, s80, 1
  s_and_b32 s15, s80, 1
  s_mul_i32 s12, s14, 16640
  s_lshl_b32 s11, s15, 8
  s_add_u32 s12, s12, s11
  s_add_u32 s12, s12, 0
  v_add_u32 v166, s12, v166
  v_lshlrev_b32 v18, 1, v16
  v_sub_u32 v18, v17, v18
  v_add_u32 v18, 30, v18
  v_lshlrev_b32 v167, 4, v18
  s_mul_i32 s13, s14, 4608
  s_add_u32 s12, s13, s11
  s_add_u32 s12, s12, 33280
  v_add_u32 v167, s12, v167
  v_lshlrev_b32 v18, 2, v16
  v_add_u32 v18, v18, v17
  v_lshlrev_b32 v18, 3, v18
  s_lshl_b32 s11, s15, 11
  s_sub_u32 s13, s13, s11
  s_add_u32 s13, s13, 35832
  v_sub_u32 v168, s13, v18
  v_lshrrev_b32 v16, 3, v1
  v_and_b32 v17, 7, v1
  v_bfe_u32 v18, v1, 4, 1
  v_lshlrev_b32 v18, 1, v18
  v_xor_b32 v17, v17, v18
  v_lshlrev_b32 v17, 4, v17
  v_mul_u32_u24 v16, 4096, v16
  v_add_u32 v172, v16, v17
  v_xor_b32 v17, 64, v17
  v_add_u32 v16, v16, v17
  v_add_u32 v173, 31744, v16
  v_add_u32 v174, 63488, v172
  v_add_u32 v175, 95232, v16
  s_mul_i32 s97, s80, 1835008
  s_lshl_b32 s96, s84, 7
  s_add_u32 s97, s97, s96
  s_add_u32 s95, s97, 1835008
  s_mul_i32 s96, s83, 262144
  s_add_u32 s97, s97, s96
  s_mul_i32 s96, s80, 24576
  s_add_u32 s96, s96, 51712
  s_add_u32 s8, s80, 1
  s_and_b32 s8, s8, 3
  s_mul_i32 s8, s8, 24576
  s_add_u32 s8, s8, 64000
  v_add_u32 v12, s8, v2
  s_add_u32 s8, s80, 2
  s_and_b32 s8, s8, 3
  s_mul_i32 s8, s8, 24576
  s_add_u32 s8, s8, 68096
  v_add_u32 v13, s8, v2
  s_add_u32 s8, s80, 3
  s_and_b32 s8, s8, 3
  s_mul_i32 s8, s8, 24576
  s_add_u32 s8, s8, 72192
  v_add_u32 v14, s8, v2
  s_mul_i32 s8, s80, 24576
  s_add_u32 s8, s8, 64000
  v_add_u32 v15, s8, v2
  s_add_u32 m0, s96, 0
  s_nop 0
  buffer_load_dwordx4 v172, s[64:67], s97 offen offset:0 lds
  buffer_load_dwordx4 v173, s[64:67], s97 offen offset:1024 lds
  buffer_load_dwordx4 v174, s[64:67], s97 offen offset:2048 lds
  buffer_load_dwordx4 v175, s[64:67], s97 offen offset:3072 lds
  s_add_u32 s97, s97, 131072
  s_add_u32 m0, s96, 4096
  s_nop 0
  buffer_load_dwordx4 v172, s[64:67], s97 offen offset:0 lds
  buffer_load_dwordx4 v173, s[64:67], s97 offen offset:1024 lds
  buffer_load_dwordx4 v174, s[64:67], s97 offen offset:2048 lds
  buffer_load_dwordx4 v175, s[64:67], s97 offen offset:3072 lds
  s_add_u32 s97, s97, 131072
  s_cmp_eq_u32 s97, s95
  s_cselect_b32 s100, 1835008, 0
  s_sub_u32 s97, s97, s100
  s_lshl_b32 s8, s83, 5
  s_mul_i32 s10, s8, 128
  s_add_u32 s10, s10, 8519680
  v_min_u32 v30, 31, v1
  v_mul_u32_u24 v30, 128, v30
  buffer_load_dword v31, v30, s[76:79], s10 offen sc1
  s_waitcnt vmcnt(0)
  s_mov_b32 s9, 0
P10:
  v_cmp_ne_u32 vcc, s85, v31
  s_nop 4
  s_cbranch_vccz Q11
  s_sleep 4
  buffer_load_dword v31, v30, s[76:79], s10 offen sc1
  s_add_u32 s9, s9, 1
  s_cmp_lt_u32 s9, 0x40000
  s_waitcnt vmcnt(0)
  s_cbranch_scc1 P10
Q11:
  s_lshl_b32 s8, s83, 6
  s_lshl_b32 s9, s84, 1
  s_add_u32 s8, s8, s9
  s_lshr_b32 s9, s80, 1
  s_add_u32 s8, s8, s9
  s_mul_i32 s8, s8, 4096
  s_and_b32 s9, s80, 1
  s_lshl_b32 s9, s9, 11
  s_add_u32 s8, s8, s9
  s_add_u32 s8, s8, 4194304
  buffer_load_dwordx4 v[240:243], v2, s[76:79], s8 offen sc1
  buffer_load_dwordx4 v[244:247], v2, s[76:79], s8 offen offset:1024 sc1
  ds_write_b128 v3, v[176:179] offset:0
  v_alignbit_b32 v188, v177, v176, 16
  v_alignbit_b32 v189, v178, v177, 16
  v_alignbit_b32 v190, v179, v178, 16
  v_alignbit_b32 v191, v180, v179, 16
  ds_write_b128 v3, v[188:191] offset:4160
  v_mov_b32 v192, v177
  v_mov_b32 v193, v178
  v_mov_b32 v194, v179
  v_mov_b32 v195, v180
  ds_write_b128 v3, v[192:195] offset:8320
  v_alignbit_b32 v179, v181, v180, 16
  v_mov_b32 v176, v189
  v_mov_b32 v177, v190
  v_mov_b32 v178, v191
  ds_write_b128 v3, v[176:179] offset:12480
  ds_write_b128 v3, v[182:185] offset:1024
  v_alignbit_b32 v196, v183, v182, 16
  v_alignbit_b32 v197, v184, v183, 16
  v_alignbit_b32 v198, v185, v184, 16
  v_alignbit_b32 v199, v186, v185, 16
  ds_write_b128 v3, v[196:199] offset:5184
  v_mov_b32 v200, v183
  v_mov_b32 v201, v184
  v_mov_b32 v202, v185
  v_mov_b32 v203, v186
  ds_write_b128 v3, v[200:203] offset:9344
  v_alignbit_b32 v185, v187, v186, 16
  v_mov_b32 v182, v197
  v_mov_b32 v183, v198
  v_mov_b32 v184, v199
  ds_write_b128 v3, v[182:185] offset:13504
  v_and_b32 v19, 3, v1
  v_lshlrev_b32 v22, 4, v19
  v_sub_u32 v22, 48, v22
  v_lshlrev_b64 v[26:27], v22, v[20:21]
  v_lshlrev_b64 v[26:27], 16, v[26:27]
  v_mov_b64 v[20:21], 0
  v_mov_b64 v[22:23], 0
  v_mov_b64 v[24:25], 0
  v_and_b32 v19, 7, v1
  v_mul_u32_u24 v19, 4160, v19
  s_mov_b64 exec, 0xff
  ds_write_b128 v19, v[20:23] offset:0
  ds_write_b128 v19, v[24:27] offset:16
  s_mov_b64 exec, -1
  s_and_b32 s15, s80, 1
  s_lshl_b32 s12, s80, 12
  s_add_u32 s12, s12, 0
  v_add_u32 v25, s12, v2
  s_xor_b32 s12, s80, 1
  s_lshl_b32 s12, s12, 12
  s_add_u32 s12, s12, 0
  v_add_u32 v26, s12, v2
  v_bfe_u32 v27, v1, 4, 1
  v_lshlrev_b32 v27, 9, v27
  v_and_b32 v17, 15, v1
  v_lshl_add_u32 v27, v17, 5, v27
  v_lshrrev_b32 v17, 5, v1
  v_lshl_add_u32 v27, v17, 4, v27
  s_lshl_b32 s12, s83, 6
  s_lshl_b32 s9, s84, 1
  s_add_u32 s12, s12, s9
  s_lshr_b32 s9, s80, 1
  s_add_u32 s12, s12, s9
  s_mul_i32 s12, s12, 4096
  s_lshl_b32 s9, s15, 11
  s_add_u32 s12, s12, s9
  s_add_u32 s12, s12, 6291456
  v_and_b32 v17, 15, v1
  v_bfe_u32 v18, v1, 4, 1
  v_lshrrev_b32 v16, 5, v1
  v_lshlrev_b32 v18, 5, v18
  v_lshl_add_u32 v18, v16, 4, v18
  v_mul_u32_u24 v16, 896, v17
  v_add_u32 v10, v16, v18
  v_lshlrev_b32 v160, 3, v17
  v_lshlrev_b32 v161, 1, v17
  v_mul_u32_u24 v4, 2048, v18
  v_add_u32 v4, v4, v161
  s_lshl_b32 s14, s84, 6
  s_lshl_b32 s9, s80, 4
  s_add_u32 s14, s14, s9
  s_mul_i32 s99, s14, 896
  s_lshl_b32 s9, s83, 7
  s_add_u32 s99, s99, s9
  s_lshl_b32 s13, s14, 3
  s_add_u32 s13, s13, 8388608
  s_lshl_b32 s14, s14, 1
  s_waitcnt vmcnt(0)
  s_lshr_b32 s8, s80, 1
  s_mul_i32 s8, s8, 4608
  s_and_b32 s9, s80, 1
  s_lshl_b32 s10, s9, 11
  s_add_u32 s10, s10, s8
  v_add_u32 v19, s10, v2
  ds_write_b128 v19, v[240:243] offset:33280
  ds_write_b128 v19, v[244:247] offset:34304
  s_lshl_b32 s9, s9, 8
  s_add_u32 s8, s8, s9
  v_add_u32 v19, s8, v2
  v_mov_b64 v[20:21], 0
  v_mov_b64 v[22:23], 0
  s_mov_b64 exec, 0xffff
  ds_write_b128 v19, v[20:23] offset:37376
  s_mov_b64 exec, -1
  s_mov_b32 s17, 0x100
COMMON:
  s_waitcnt lgkmcnt(0)
  s_barrier
  ds_read_b64 v[32:33], v166 offset:0
  ds_read_b64 v[34:35], v166 offset:8
  ds_read_b128 v[96:99], v167 offset:3584
  ds_read_b64 v[36:37], v166 offset:512
  ds_read_b64 v[38:39], v166 offset:520
  ds_read_b128 v[100:103], v167 offset:3072
  ds_read_b64 v[40:41], v166 offset:1024
  ds_read_b64 v[42:43], v166 offset:1032
  ds_read_b128 v[104:107], v167 offset:2560
  ds_read_b64 v[44:45], v166 offset:1536
  ds_read_b64 v[46:47], v166 offset:1544
  ds_read_b128 v[108:111], v167 offset:2048
  ds_read_b64 v[48:49], v166 offset:2048
  ds_read_b64 v[50:51], v166 offset:2056
  ds_read_b128 v[112:115], v167 offset:1536
  ds_read_b64 v[52:53], v166 offset:2560
  ds_read_b64 v[54:55], v166 offset:2568
  ds_read_b128 v[116:119], v167 offset:1024
  ds_read_b64 v[56:57], v166 offset:3072
  ds_read_b64 v[58:59], v166 offset:3080
  ds_read_b128 v[120:123], v167 offset:512
  ds_read_b64 v[60:61], v166 offset:3584
  ds_read_b64 v[62:63], v166 offset:3592
  ds_read_b128 v[124:127], v167 offset:0
  s_waitcnt lgkmcnt(0)
  v_mfma_f32_16x16x32_bf16 v[176:179], v[32:35], v[96:99], 0
  ds_read_b64 v[64:65], v166 offset:64
  s_add_u32 m0, s96, 8192
  v_mfma_f32_16x16x32_bf16 v[180:183], v[32:35], v[100:103], 0
  ds_read_b64 v[66:67], v166 offset:72
  buffer_load_dwordx4 v172, s[64:67], s97 offen offset:0 lds
  v_mfma_f32_16x16x32_bf16 v[184:187], v[32:35], v[104:107], 0
  ds_read_b128 v[128:131], v167 offset:3648
  v_mfma_f32_16x16x32_bf16 v[188:191], v[32:35], v[108:111], 0
  ds_read_b64 v[68:69], v166 offset:576
  buffer_load_dwordx4 v173, s[64:67], s97 offen offset:1024 lds
  v_mfma_f32_16x16x32_bf16 v[192:195], v[32:35], v[112:115], 0
  ds_read_b64 v[70:71], v166 offset:584
  v_mfma_f32_16x16x32_bf16 v[196:199], v[32:35], v[116:119], 0
  ds_read_b128 v[132:135], v167 offset:3136
  buffer_load_dwordx4 v174, s[64:67], s97 offen offset:2048 lds
  v_mfma_f32_16x16x32_bf16 v[200:203], v[32:35], v[120:123], 0
  ds_read_b64 v[72:73], v166 offset:1088
  v_mfma_f32_16x16x32_bf16 v[204:207], v[32:35], v[124:127], 0
  ds_read_b64 v[74:75], v166 offset:1096
  buffer_load_dwordx4 v175, s[64:67], s97 offen offset:3072 lds
  v_mfma_f32_16x16x32_bf16 v[180:183], v[36:39], v[96:99], v[180:183]
  ds_read_b128 v[136:139], v167 offset:2624
  s_add_u32 s97, s97, 131072
  v_mfma_f32_16x16x32_bf16 v[184:187], v[36:39], v[100:103], v[184:187]
  ds_read_b64 v[76:77], v166 offset:1600
  s_add_u32 m0, s96, 12288
  v_mfma_f32_16x16x32_bf16 v[188:191], v[36:39], v[104:107], v[188:191]
  ds_read_b64 v[78:79], v166 offset:1608
  buffer_load_dwordx4 v172, s[64:67], s97 offen offset:0 lds
  v_mfma_f32_16x16x32_bf16 v[192:195], v[36:39], v[108:111], v[192:195]
  ds_read_b128 v[140:143], v167 offset:2112
  v_mfma_f32_16x16x32_bf16 v[196:199], v[36:39], v[112:115], v[196:199]
  ds_read_b64 v[80:81], v166 offset:2112
  buffer_load_dwordx4 v173, s[64:67], s97 offen offset:1024 lds
  v_mfma_f32_16x16x32_bf16 v[200:203], v[36:39], v[116:119], v[200:203]
  ds_read_b64 v[82:83], v166 offset:2120
  v_mfma_f32_16x16x32_bf16 v[204:207], v[36:39], v[120:123], v[204:207]
  ds_read_b128 v[144:147], v167 offset:1600
  buffer_load_dwordx4 v174, s[64:67], s97 offen offset:2048 lds
  v_mfma_f32_16x16x32_bf16 v[184:187], v[40:43], v[96:99], v[184:187]
  ds_read_b64 v[84:85], v166 offset:2624
  v_mfma_f32_16x16x32_bf16 v[188:191], v[40:43], v[100:103], v[188:191]
  ds_read_b64 v[86:87], v166 offset:2632
  buffer_load_dwordx4 v175, s[64:67], s97 offen offset:3072 lds
  v_mfma_f32_16x16x32_bf16 v[192:195], v[40:43], v[104:107], v[192:195]
  ds_read_b128 v[148:151], v167 offset:1088
  s_add_u32 s97, s97, 131072
  s_cmp_eq_u32 s97, s95
  s_cselect_b32 s100, 1835008, 0
  s_sub_u32 s97, s97, s100
  v_mfma_f32_16x16x32_bf16 v[196:199], v[40:43], v[108:111], v[196:199]
  ds_read_b64 v[88:89], v166 offset:3136
  s_waitcnt vmcnt(10)
  ds_read_b64_tr_b16 a[0:1], v5 offset:0
  v_mfma_f32_16x16x32_bf16 v[200:203], v[40:43], v[112:115], v[200:203]
  ds_read_b64 v[90:91], v166 offset:3144
  ds_read_b64_tr_b16 a[2:3], v5 offset:512
  v_mfma_f32_16x16x32_bf16 v[204:207], v[40:43], v[116:119], v[204:207]
  ds_read_b128 v[152:155], v167 offset:576
  ds_read_b64_tr_b16 a[4:5], v6 offset:0
  v_mfma_f32_16x16x32_bf16 v[188:191], v[44:47], v[96:99], v[188:191]
  ds_read_b64 v[92:93], v166 offset:3648
  ds_read_b64_tr_b16 a[6:7], v6 offset:512
  v_mfma_f32_16x16x32_bf16 v[192:195], v[44:47], v[100:103], v[192:195]
  ds_read_b64 v[94:95], v166 offset:3656
  ds_read_b64_tr_b16 a[8:9], v7 offset:0
  v_mfma_f32_16x16x32_bf16 v[196:199], v[44:47], v[104:107], v[196:199]
  ds_read_b128 v[156:159], v167 offset:64
  ds_read_b64_tr_b16 a[10:11], v7 offset:512
  v_mfma_f32_16x16x32_bf16 v[200:203], v[44:47], v[108:111], v[200:203]
  ds_read_b64_tr_b16 a[12:13], v8 offset:0
  ds_read_b64_tr_b16 a[14:15], v8 offset:512
  v_mfma_f32_16x16x32_bf16 v[204:207], v[44:47], v[112:115], v[204:207]
  s_add_u32 m0, s96, 16384
  s_nop 0
  buffer_load_dwordx4 v172, s[64:67], s97 offen offset:0 lds
  v_mfma_f32_16x16x32_bf16 v[192:195], v[48:51], v[96:99], v[192:195]
  v_mfma_f32_16x16x32_bf16 v[196:199], v[48:51], v[100:103], v[196:199]
  buffer_load_dwordx4 v173, s[64:67], s97 offen offset:1024 lds
  v_mfma_f32_16x16x32_bf16 v[200:203], v[48:51], v[104:107], v[200:203]
  v_mfma_f32_16x16x32_bf16 v[204:207], v[48:51], v[108:111], v[204:207]
  buffer_load_dwordx4 v174, s[64:67], s97 offen offset:2048 lds
  v_mfma_f32_16x16x32_bf16 v[196:199], v[52:55], v[96:99], v[196:199]
  v_mfma_f32_16x16x32_bf16 v[200:203], v[52:55], v[100:103], v[200:203]
  buffer_load_dwordx4 v175, s[64:67], s97 offen offset:3072 lds
  s_add_u32 s97, s97, 131072
  v_mfma_f32_16x16x32_bf16 v[204:207], v[52:55], v[104:107], v[204:207]
  s_waitcnt vmcnt(14)
  ds_read_b64_tr_b16 a[16:17], v5 offset:4096
  v_mfma_f32_16x16x32_bf16 v[200:203], v[56:59], v[96:99], v[200:203]
  ds_read_b64_tr_b16 a[18:19], v5 offset:4608
  ds_read_b64_tr_b16 a[20:21], v6 offset:4096
  v_mfma_f32_16x16x32_bf16 v[204:207], v[56:59], v[100:103], v[204:207]
  s_waitcnt vmcnt(12)
  s_mov_b32 s8, s17
  s_mul_i32 s8, s8, 128
  s_add_u32 s8, s8, 8585216
  s_cmp_eq_u32 s80, 0
  s_cselect_b32 s8, s8, 1073741824
  v_mov_b32 v30, s85
  v_mov_b32 v31, 0
  s_barrier
  s_mov_b64 exec, 1
  buffer_store_dword v30, v31, s[76:79], s8 offen sc1
  s_mov_b64 exec, -1
  v_mfma_f32_16x16x32_bf16 v[204:207], v[60:63], v[96:99], v[204:207]
  ds_read_b64_tr_b16 a[22:23], v6 offset:4608
  ds_read_b64_tr_b16 a[24:25], v7 offset:4096
  s_waitcnt lgkmcnt(0)
  v_mfma_f32_16x16x32_bf16 v[176:179], v[64:67], v[128:131], v[176:179]
  ds_read_b64 v[32:33], v166 offset:128
  ds_read_b64_tr_b16 a[26:27], v7 offset:4608
  v_mfma_f32_16x16x32_bf16 v[180:183], v[64:67], v[132:135], v[180:183]
  ds_read_b64 v[34:35], v166 offset:136
  ds_read_b64_tr_b16 a[28:29], v8 offset:4096
  v_mfma_f32_16x16x32_bf16 v[184:187], v[64:67], v[136:139], v[184:187]
  ds_read_b128 v[96:99], v167 offset:3712
  ds_read_b64_tr_b16 a[30:31], v8 offset:4608
  v_mfma_f32_16x16x32_bf16 v[188:191], v[64:67], v[140:143], v[188:191]
  ds_read_b64 v[36:37], v166 offset:640
  s_add_u32 m0, s96, 20480
  v_mfma_f32_16x16x32_bf16 v[192:195], v[64:67], v[144:147], v[192:195]
  ds_read_b64 v[38:39], v166 offset:648
  buffer_load_dwordx4 v172, s[64:67], s97 offen offset:0 lds
  v_mfma_f32_16x16x32_bf16 v[196:199], v[64:67], v[148:151], v[196:199]
  ds_read_b128 v[100:103], v167 offset:3200
  v_mfma_f32_16x16x32_bf16 v[200:203], v[64:67], v[152:155], v[200:203]
  ds_read_b64 v[40:41], v166 offset:1152
  buffer_load_dwordx4 v173, s[64:67], s97 offen offset:1024 lds
  v_mfma_f32_16x16x32_bf16 v[204:207], v[64:67], v[156:159], v[204:207]
  ds_read_b64 v[42:43], v166 offset:1160
  v_mfma_f32_16x16x32_bf16 v[180:183], v[68:71], v[128:131], v[180:183]
  ds_read_b128 v[104:107], v167 offset:2688
  buffer_load_dwordx4 v174, s[64:67], s97 offen offset:2048 lds
  v_mfma_f32_16x16x32_bf16 v[184:187], v[68:71], v[132:135], v[184:187]
  ds_read_b64 v[44:45], v166 offset:1664
  v_mfma_f32_16x16x32_bf16 v[188:191], v[68:71], v[136:139], v[188:191]
  ds_read_b64 v[46:47], v166 offset:1672
  buffer_load_dwordx4 v175, s[64:67], s97 offen offset:3072 lds
  v_mfma_f32_16x16x32_bf16 v[192:195], v[68:71], v[140:143], v[192:195]
  ds_read_b128 v[108:111], v167 offset:2176
  s_add_u32 s97, s97, 131072
  s_cmp_eq_u32 s97, s95
  s_cselect_b32 s100, 1835008, 0
  s_sub_u32 s97, s97, s100
  v_mfma_f32_16x16x32_bf16 v[196:199], v[68:71], v[144:147], v[196:199]
  ds_read_b64 v[48:49], v166 offset:2176
  s_waitcnt vmcnt(13)
  ds_read_b64_tr_b16 a[32:33], v5 offset:8192
  v_mfma_f32_16x16x32_bf16 v[200:203], v[68:71], v[148:151], v[200:203]
  ds_read_b64 v[50:51], v166 offset:2184
  ds_read_b64_tr_b16 a[34:35], v5 offset:8704
  v_mfma_f32_16x16x32_bf16 v[204:207], v[68:71], v[152:155], v[204:207]
  ds_read_b128 v[112:115], v167 offset:1664
  ds_read_b64_tr_b16 a[36:37], v6 offset:8192
  v_mfma_f32_16x16x32_bf16 v[184:187], v[72:75], v[128:131], v[184:187]
  ds_read_b64 v[52:53], v166 offset:2688
  ds_read_b64_tr_b16 a[38:39], v6 offset:8704
  v_mfma_f32_16x16x32_bf16 v[188:191], v[72:75], v[132:135], v[188:191]
  ds_read_b64 v[54:55], v166 offset:2696
  ds_read_b64_tr_b16 a[40:41], v7 offset:8192
  v_mfma_f32_16x16x32_bf16 v[192:195], v[72:75], v[136:139], v[192:195]
  ds_read_b128 v[116:119], v167 offset:1152
  ds_read_b64_tr_b16 a[42:43], v7 offset:8704
  v_mfma_f32_16x16x32_bf16 v[196:199], v[72:75], v[140:143], v[196:199]
  ds_read_b64 v[56:57], v166 offset:3200
  ds_read_b64_tr_b16 a[44:45], v8 offset:8192
  v_mfma_f32_16x16x32_bf16 v[200:203], v[72:75], v[144:147], v[200:203]
  ds_read_b64 v[58:59], v166 offset:3208
  ds_read_b64_tr_b16 a[46:47], v8 offset:8704
  v_mfma_f32_16x16x32_bf16 v[204:207], v[72:75], v[148:151], v[204:207]
  ds_read_b128 v[120:123], v167 offset:640
  s_add_u32 m0, s96, 0
  v_mfma_f32_16x16x32_bf16 v[188:191], v[76:79], v[128:131], v[188:191]
  ds_read_b64 v[60:61], v166 offset:3712
  buffer_load_dwordx4 v172, s[64:67], s97 offen offset:0 lds
  v_mfma_f32_16x16x32_bf16 v[192:195], v[76:79], v[132:135], v[192:195]
  ds_read_b64 v[62:63], v166 offset:3720
  v_mfma_f32_16x16x32_bf16 v[196:199], v[76:79], v[136:139], v[196:199]
  ds_read_b128 v[124:127], v167 offset:128
  buffer_load_dwordx4 v173, s[64:67], s97 offen offset:1024 lds
  v_mfma_f32_16x16x32_bf16 v[200:203], v[76:79], v[140:143], v[200:203]
  v_mfma_f32_16x16x32_bf16 v[204:207], v[76:79], v[144:147], v[204:207]
  buffer_load_dwordx4 v174, s[64:67], s97 offen offset:2048 lds
  v_mfma_f32_16x16x32_bf16 v[192:195], v[80:83], v[128:131], v[192:195]
  v_mfma_f32_16x16x32_bf16 v[196:199], v[80:83], v[132:135], v[196:199]
  buffer_load_dwordx4 v175, s[64:67], s97 offen offset:3072 lds
  s_add_u32 s97, s97, 131072
  v_mfma_f32_16x16x32_bf16 v[200:203], v[80:83], v[136:139], v[200:203]
  s_waitcnt vmcnt(13)
  ds_read_b64_tr_b16 a[48:49], v5 offset:12288
  v_mfma_f32_16x16x32_bf16 v[204:207], v[80:83], v[140:143], v[204:207]
  ds_read_b64_tr_b16 a[50:51], v5 offset:12800
  ds_read_b64_tr_b16 a[52:53], v6 offset:12288
  v_mfma_f32_16x16x32_bf16 v[196:199], v[84:87], v[128:131], v[196:199]
  ds_read_b64_tr_b16 a[54:55], v6 offset:12800
  ds_read_b64_tr_b16 a[56:57], v7 offset:12288
  v_mfma_f32_16x16x32_bf16 v[200:203], v[84:87], v[132:135], v[200:203]
  ds_read_b64_tr_b16 a[58:59], v7 offset:12800
  ds_read_b64_tr_b16 a[60:61], v8 offset:12288
  v_mfma_f32_16x16x32_bf16 v[204:207], v[84:87], v[136:139], v[204:207]
  ds_read_b64_tr_b16 a[62:63], v8 offset:12800
  v_mfma_f32_16x16x32_bf16 v[200:203], v[88:91], v[128:131], v[200:203]
  v_mfma_f32_16x16x32_bf16 v[204:207], v[88:91], v[132:135], v[204:207]
  v_mfma_f32_16x16x32_bf16 v[204:207], v[92:95], v[128:131], v[204:207]
  s_waitcnt lgkmcnt(0)
  v_mfma_f32_16x16x32_bf16 v[176:179], v[32:35], v[96:99], v[176:179]
  ds_read_b64 v[64:65], v166 offset:192
  s_add_u32 m0, s96, 4096
  v_mfma_f32_16x16x32_bf16 v[180:183], v[32:35], v[100:103], v[180:183]
  ds_read_b64 v[66:67], v166 offset:200
  buffer_load_dwordx4 v172, s[64:67], s97 offen offset:0 lds
  v_mfma_f32_16x16x32_bf16 v[184:187], v[32:35], v[104:107], v[184:187]
  ds_read_b128 v[128:131], v167 offset:3776
  v_mfma_f32_16x16x32_bf16 v[188:191], v[32:35], v[108:111], v[188:191]
  ds_read_b64 v[68:69], v166 offset:704
  buffer_load_dwordx4 v173, s[64:67], s97 offen offset:1024 lds
  v_mfma_f32_16x16x32_bf16 v[192:195], v[32:35], v[112:115], v[192:195]
  ds_read_b64 v[70:71], v166 offset:712
  v_mfma_f32_16x16x32_bf16 v[196:199], v[32:35], v[116:119], v[196:199]
  ds_read_b128 v[132:135], v167 offset:3264
  buffer_load_dwordx4 v174, s[64:67], s97 offen offset:2048 lds
  v_mfma_f32_16x16x32_bf16 v[200:203], v[32:35], v[120:123], v[200:203]
  ds_read_b64 v[72:73], v166 offset:1216
  v_mfma_f32_16x16x32_bf16 v[204:207], v[32:35], v[124:127], v[204:207]
  ds_read_b64 v[74:75], v166 offset:1224
  buffer_load_dwordx4 v175, s[64:67], s97 offen offset:3072 lds
  v_mfma_f32_16x16x32_bf16 v[180:183], v[36:39], v[96:99], v[180:183]
  ds_read_b128 v[136:139], v167 offset:2752
  s_add_u32 s97, s97, 131072
  s_cmp_eq_u32 s97, s95
  s_cselect_b32 s100, 1835008, 0
  s_sub_u32 s97, s97, s100
  v_mfma_f32_16x16x32_bf16 v[184:187], v[36:39], v[100:103], v[184:187]
  ds_read_b64 v[76:77], v166 offset:1728
  s_waitcnt vmcnt(13)
  ds_read_b64_tr_b16 a[64:65], v5 offset:16384
  v_mfma_f32_16x16x32_bf16 v[188:191], v[36:39], v[104:107], v[188:191]
  ds_read_b64 v[78:79], v166 offset:1736
  ds_read_b64_tr_b16 a[66:67], v5 offset:16896
  v_mfma_f32_16x16x32_bf16 v[192:195], v[36:39], v[108:111], v[192:195]
  ds_read_b128 v[140:143], v167 offset:2240
  ds_read_b64_tr_b16 a[68:69], v6 offset:16384
  v_mfma_f32_16x16x32_bf16 v[196:199], v[36:39], v[112:115], v[196:199]
  ds_read_b64 v[80:81], v166 offset:2240
  ds_read_b64_tr_b16 a[70:71], v6 offset:16896
  v_mfma_f32_16x16x32_bf16 v[200:203], v[36:39], v[116:119], v[200:203]
  ds_read_b64 v[82:83], v166 offset:2248
  ds_read_b64_tr_b16 a[72:73], v7 offset:16384
  v_mfma_f32_16x16x32_bf16 v[204:207], v[36:39], v[120:123], v[204:207]
  ds_read_b128 v[144:147], v167 offset:1728
  ds_read_b64_tr_b16 a[74:75], v7 offset:16896
  v_mfma_f32_16x16x32_bf16 v[184:187], v[40:43], v[96:99], v[184:187]
  ds_read_b64 v[84:85], v166 offset:2752
  ds_read_b64_tr_b16 a[76:77], v8 offset:16384
  v_mfma_f32_16x16x32_bf16 v[188:191], v[40:43], v[100:103], v[188:191]
  ds_read_b64 v[86:87], v166 offset:2760
  ds_read_b64_tr_b16 a[78:79], v8 offset:16896
  v_mfma_f32_16x16x32_bf16 v[192:195], v[40:43], v[104:107], v[192:195]
  ds_read_b128 v[148:151], v167 offset:1216
  s_add_u32 m0, s96, 8192
  v_mfma_f32_16x16x32_bf16 v[196:199], v[40:43], v[108:111], v[196:199]
  ds_read_b64 v[88:89], v166 offset:3264
  buffer_load_dwordx4 v172, s[64:67], s97 offen offset:0 lds
  v_mfma_f32_16x16x32_bf16 v[200:203], v[40:43], v[112:115], v[200:203]
  ds_read_b64 v[90:91], v166 offset:3272
  v_mfma_f32_16x16x32_bf16 v[204:207], v[40:43], v[116:119], v[204:207]
  ds_read_b128 v[152:155], v167 offset:704
  buffer_load_dwordx4 v173, s[64:67], s97 offen offset:1024 lds
  v_mfma_f32_16x16x32_bf16 v[188:191], v[44:47], v[96:99], v[188:191]
  ds_read_b64 v[92:93], v166 offset:3776
  v_mfma_f32_16x16x32_bf16 v[192:195], v[44:47], v[100:103], v[192:195]
  ds_read_b64 v[94:95], v166 offset:3784
  buffer_load_dwordx4 v174, s[64:67], s97 offen offset:2048 lds
  v_mfma_f32_16x16x32_bf16 v[196:199], v[44:47], v[104:107], v[196:199]
  ds_read_b128 v[156:159], v167 offset:192
  v_mfma_f32_16x16x32_bf16 v[200:203], v[44:47], v[108:111], v[200:203]
  buffer_load_dwordx4 v175, s[64:67], s97 offen offset:3072 lds
  s_add_u32 s97, s97, 131072
  v_mfma_f32_16x16x32_bf16 v[204:207], v[44:47], v[112:115], v[204:207]
  s_waitcnt vmcnt(12)
  ds_read_b64_tr_b16 a[80:81], v5 offset:20480
  v_mfma_f32_16x16x32_bf16 v[192:195], v[48:51], v[96:99], v[192:195]
  ds_read_b64_tr_b16 a[82:83], v5 offset:20992
  ds_read_b64_tr_b16 a[84:85], v6 offset:20480
  v_mfma_f32_16x16x32_bf16 v[196:199], v[48:51], v[100:103], v[196:199]
  ds_read_b64_tr_b16 a[86:87], v6 offset:20992
  ds_read_b64_tr_b16 a[88:89], v7 offset:20480
  v_mfma_f32_16x16x32_bf16 v[200:203], v[48:51], v[104:107], v[200:203]
  ds_read_b64_tr_b16 a[90:91], v7 offset:20992
  ds_read_b64_tr_b16 a[92:93], v8 offset:20480
  v_mfma_f32_16x16x32_bf16 v[204:207], v[48:51], v[108:111], v[204:207]
  ds_read_b64_tr_b16 a[94:95], v8 offset:20992
  s_add_u32 m0, s96, 12288
  v_mfma_f32_16x16x32_bf16 v[196:199], v[52:55], v[96:99], v[196:199]
  buffer_load_dwordx4 v172, s[64:67], s97 offen offset:0 lds
  v_mfma_f32_16x16x32_bf16 v[200:203], v[52:55], v[100:103], v[200:203]
  v_mfma_f32_16x16x32_bf16 v[204:207], v[52:55], v[104:107], v[204:207]
  buffer_load_dwordx4 v173, s[64:67], s97 offen offset:1024 lds
  v_mfma_f32_16x16x32_bf16 v[200:203], v[56:59], v[96:99], v[200:203]
  v_mfma_f32_16x16x32_bf16 v[204:207], v[56:59], v[100:103], v[204:207]
  buffer_load_dwordx4 v174, s[64:67], s97 offen offset:2048 lds
  v_mfma_f32_16x16x32_bf16 v[204:207], v[60:63], v[96:99], v[204:207]
  s_waitcnt lgkmcnt(0)
  v_mfma_f32_16x16x32_bf16 v[176:179], v[64:67], v[128:131], v[176:179]
  buffer_load_dwordx4 v175, s[64:67], s97 offen offset:3072 lds
  s_add_u32 s97, s97, 131072
  s_cmp_eq_u32 s97, s95
  s_cselect_b32 s100, 1835008, 0
  s_sub_u32 s97, s97, s100
  v_mfma_f32_16x16x32_bf16 v[180:183], v[64:67], v[132:135], v[180:183]
  s_waitcnt vmcnt(12)
  ds_read_b64_tr_b16 a[96:97], v5 offset:0
  v_mfma_f32_16x16x32_bf16 v[184:187], v[64:67], v[136:139], v[184:187]
  ds_read_b64_tr_b16 a[98:99], v5 offset:512
  ds_read_b64_tr_b16 a[100:101], v6 offset:0
  v_mfma_f32_16x16x32_bf16 v[188:191], v[64:67], v[140:143], v[188:191]
  ds_read_b64_tr_b16 a[102:103], v6 offset:512
  ds_read_b64_tr_b16 a[104:105], v7 offset:0
  v_mfma_f32_16x16x32_bf16 v[192:195], v[64:67], v[144:147], v[192:195]
  ds_read_b64_tr_b16 a[106:107], v7 offset:512
  ds_read_b64_tr_b16 a[108:109], v8 offset:0
  v_mfma_f32_16x16x32_bf16 v[196:199], v[64:67], v[148:151], v[196:199]
  ds_read_b64_tr_b16 a[110:111], v8 offset:512
  s_add_u32 m0, s96, 16384
  v_mfma_f32_16x16x32_bf16 v[200:203], v[64:67], v[152:155], v[200:203]
  buffer_load_dwordx4 v172, s[64:67], s97 offen offset:0 lds
  v_mfma_f32_16x16x32_bf16 v[204:207], v[64:67], v[156:159], v[204:207]
  v_mfma_f32_16x16x32_bf16 v[180:183], v[68:71], v[128:131], v[180:183]
  buffer_load_dwordx4 v173, s[64:67], s97 offen offset:1024 lds
  v_mfma_f32_16x16x32_bf16 v[184:187], v[68:71], v[132:135], v[184:187]
  v_mfma_f32_16x16x32_bf16 v[188:191], v[68:71], v[136:139], v[188:191]
  buffer_load_dwordx4 v174, s[64:67], s97 offen offset:2048 lds
  v_mfma_f32_16x16x32_bf16 v[192:195], v[68:71], v[140:143], v[192:195]
  v_mfma_f32_16x16x32_bf16 v[196:199], v[68:71], v[144:147], v[196:199]
  buffer_load_dwordx4 v175, s[64:67], s97 offen offset:3072 lds
  s_add_u32 s97, s97, 131072
  v_mfma_f32_16x16x32_bf16 v[200:203], v[68:71], v[148:151], v[200:203]
  s_waitcnt vmcnt(12)
  ds_read_b64_tr_b16 a[112:113], v5 offset:4096
  v_mfma_f32_16x16x32_bf16 v[204:207], v[68:71], v[152:155], v[204:207]
  ds_read_b64_tr_b16 a[114:115], v5 offset:4608
  ds_read_b64_tr_b16 a[116:117], v6 offset:4096
  v_mfma_f32_16x16x32_bf16 v[184:187], v[72:75], v[128:131], v[184:187]
  ds_read_b64_tr_b16 a[118:119], v6 offset:4608
  ds_read_b64_tr_b16 a[120:121], v7 offset:4096
  v_mfma_f32_16x16x32_bf16 v[188:191], v[72:75], v[132:135], v[188:191]
  s_mul_i32 s8, s83, 28
  s_mul_i32 s9, s80, 7
  s_add_u32 s8, s8, s9
  s_mul_i32 s10, s8, 128
  s_add_u32 s10, s10, 8585216
  v_min_u32 v30, 6, v1
  v_mul_u32_u24 v30, 128, v30
  buffer_load_dword v31, v30, s[76:79], s10 offen sc1
  s_lshl_b32 s8, s84, 2
  s_add_u32 s8, s8, s80
  s_lshl_b32 s8, s8, 1
  s_mul_i32 s11, s8, 16
  s_add_u32 s11, s11, 8454144
  v_min_u32 v170, 1, v1
  v_mul_u32_u24 v170, 16, v170
  buffer_load_dword v171, v170, s[76:79], s11 offen sc1
  s_mul_i32 s16, s83, 56
  s_mul_i32 s8, s80, 14
  s_add_u32 s16, s16, s8
  s_lshl_b32 s16, s16, 12
  s_add_u32 s16, s16, 2097152
  s_add_u32 s3, s16, 57344
  s_lshl_b32 s8, s83, 13
  s_add_u32 s16, s16, s8
  v_mfma_f32_16x16x32_bf16 v[192:195], v[72:75], v[136:139], v[192:195]
  ds_read_b64_tr_b16 a[122:123], v7 offset:4608
  ds_read_b64_tr_b16 a[124:125], v8 offset:4096
  v_mfma_f32_16x16x32_bf16 v[196:199], v[72:75], v[140:143], v[196:199]
  ds_read_b64_tr_b16 a[126:127], v8 offset:4608
  s_add_u32 m0, s96, 20480
  v_mfma_f32_16x16x32_bf16 v[200:203], v[72:75], v[144:147], v[200:203]
  buffer_load_dwordx4 v172, s[64:67], s97 offen offset:0 lds
  v_mfma_f32_16x16x32_bf16 v[204:207], v[72:75], v[148:151], v[204:207]
  v_mfma_f32_16x16x32_bf16 v[188:191], v[76:79], v[128:131], v[188:191]
  buffer_load_dwordx4 v173, s[64:67], s97 offen offset:1024 lds
  v_mfma_f32_16x16x32_bf16 v[192:195], v[76:79], v[132:135], v[192:195]
  v_mfma_f32_16x16x32_bf16 v[196:199], v[76:79], v[136:139], v[196:199]
  buffer_load_dwordx4 v174, s[64:67], s97 offen offset:2048 lds
  v_mfma_f32_16x16x32_bf16 v[200:203], v[76:79], v[140:143], v[200:203]
  v_mfma_f32_16x16x32_bf16 v[204:207], v[76:79], v[144:147], v[204:207]
  buffer_load_dwordx4 v175, s[64:67], s97 offen offset:3072 lds
  s_add_u32 s97, s97, 131072
  s_cmp_eq_u32 s97, s95
  s_cselect_b32 s100, 1835008, 0
  s_sub_u32 s97, s97, s100
  v_mfma_f32_16x16x32_bf16 v[192:195], v[80:83], v[128:131], v[192:195]
  s_waitcnt vmcnt(14)
  ds_read_b64_tr_b16 a[128:129], v5 offset:8192
  v_mfma_f32_16x16x32_bf16 v[196:199], v[80:83], v[132:135], v[196:199]
  ds_read_b64_tr_b16 a[130:131], v5 offset:8704
  ds_read_b64_tr_b16 a[132:133], v6 offset:8192
  v_mfma_f32_16x16x32_bf16 v[200:203], v[80:83], v[136:139], v[200:203]
  ds_read_b64_tr_b16 a[134:135], v6 offset:8704
  ds_read_b64_tr_b16 a[136:137], v7 offset:8192
  v_mfma_f32_16x16x32_bf16 v[204:207], v[80:83], v[140:143], v[204:207]
  ds_read_b64_tr_b16 a[138:139], v7 offset:8704
  ds_read_b64_tr_b16 a[140:141], v8 offset:8192
  v_mfma_f32_16x16x32_bf16 v[196:199], v[84:87], v[128:131], v[196:199]
  ds_read_b64_tr_b16 a[142:143], v8 offset:8704
  v_mfma_f32_16x16x32_bf16 v[200:203], v[84:87], v[132:135], v[200:203]
  v_mfma_f32_16x16x32_bf16 v[204:207], v[84:87], v[136:139], v[204:207]
  v_mfma_f32_16x16x32_bf16 v[200:203], v[88:91], v[128:131], v[200:203]
  v_mfma_f32_16x16x32_bf16 v[204:207], v[88:91], v[132:135], v[204:207]
  v_mfma_f32_16x16x32_bf16 v[204:207], v[92:95], v[128:131], v[204:207]
  s_add_u32 m0, s96, 0
  s_nop 0
  buffer_load_dwordx4 v172, s[64:67], s97 offen offset:0 lds
  buffer_load_dwordx4 v173, s[64:67], s97 offen offset:1024 lds
  buffer_load_dwordx4 v174, s[64:67], s97 offen offset:2048 lds
  buffer_load_dwordx4 v175, s[64:67], s97 offen offset:3072 lds
  s_add_u32 s97, s97, 131072
  s_waitcnt vmcnt(14)
  ds_read_b64_tr_b16 a[144:145], v5 offset:12288
  ds_read_b64_tr_b16 a[146:147], v5 offset:12800
  ds_read_b64_tr_b16 a[148:149], v6 offset:12288
  ds_read_b64_tr_b16 a[150:151], v6 offset:12800
  ds_read_b64_tr_b16 a[152:153], v7 offset:12288
  ds_read_b64_tr_b16 a[154:155], v7 offset:12800
  ds_read_b64_tr_b16 a[156:157], v8 offset:12288
  ds_read_b64_tr_b16 a[158:159], v8 offset:12800
  s_add_u32 m0, s96, 4096
  s_nop 0
  buffer_load_dwordx4 v172, s[64:67], s97 offen offset:0 lds
  buffer_load_dwordx4 v173, s[64:67], s97 offen offset:1024 lds
  buffer_load_dwordx4 v174, s[64:67], s97 offen offset:2048 lds
  buffer_load_dwordx4 v175, s[64:67], s97 offen offset:3072 lds
  s_add_u32 s97, s97, 131072
  s_cmp_eq_u32 s97, s95
  s_cselect_b32 s100, 1835008, 0
  s_sub_u32 s97, s97, s100
  s_waitcnt vmcnt(13)
  s_mov_b32 s9, 0
P12:
  v_cmp_ne_u32 vcc, s85, v31
  s_nop 4
  s_cbranch_vccz Q13
  s_sleep 4
  buffer_load_dword v31, v30, s[76:79], s10 offen sc1
  s_add_u32 s9, s9, 1
  s_cmp_lt_u32 s9, 0x40000
  s_waitcnt vmcnt(0)
  s_cbranch_scc1 P12
Q13:
  s_waitcnt vmcnt(12)
  s_mov_b32 s9, 0
P14:
  v_cmp_ne_u32 vcc, s85, v171
  s_nop 4
  s_cbranch_vccz Q15
  s_sleep 4
  buffer_load_dword v171, v170, s[76:79], s11 offen sc1
  s_add_u32 s9, s9, 1
  s_cmp_lt_u32 s9, 0x40000
  s_waitcnt vmcnt(0)
  s_cbranch_scc1 P14
Q15:
  buffer_load_dwordx4 v[96:99], v2, s[76:79], s16 offen offset:0 sc1
  buffer_load_dwordx4 v[100:103], v2, s[76:79], s16 offen offset:1024 sc1
  buffer_load_dwordx4 v[104:107], v2, s[76:79], s16 offen offset:2048 sc1
  buffer_load_dwordx4 v[108:111], v2, s[76:79], s16 offen offset:3072 sc1
  s_add_u32 s16, s16, 4096
  buffer_load_dwordx4 v[112:115], v2, s[76:79], s16 offen offset:0 sc1
  buffer_load_dwordx4 v[116:119], v2, s[76:79], s16 offen offset:1024 sc1
  buffer_load_dwordx4 v[120:123], v2, s[76:79], s16 offen offset:2048 sc1
  buffer_load_dwordx4 v[124:127], v2, s[76:79], s16 offen offset:3072 sc1
  s_add_u32 s16, s16, 4096
  s_cmp_eq_u32 s16, s3
  s_cselect_b32 s100, 57344, 0
  s_sub_u32 s16, s16, s100
  buffer_load_dwordx4 v[128:131], v2, s[76:79], s16 offen offset:0 sc1
  buffer_load_dwordx4 v[132:135], v2, s[76:79], s16 offen offset:1024 sc1
  buffer_load_dwordx4 v[136:139], v2, s[76:79], s16 offen offset:2048 sc1
  buffer_load_dwordx4 v[140:143], v2, s[76:79], s16 offen offset:3072 sc1
  s_add_u32 s16, s16, 4096
  buffer_load_dwordx4 v[144:147], v2, s[76:79], s16 offen offset:0 sc1
  buffer_load_dwordx4 v[148:151], v2, s[76:79], s16 offen offset:1024 sc1
  buffer_load_dwordx4 v[152:155], v2, s[76:79], s16 offen offset:2048 sc1
  buffer_load_dwordx4 v[156:159], v2, s[76:79], s16 offen offset:3072 sc1
  s_add_u32 s16, s16, 4096
  s_cmp_eq_u32 s16, s3
  s_cselect_b32 s100, 57344, 0
  s_sub_u32 s16, s16, s100
  ds_read_b64 v[240:241], v168 offset:1536
  ds_read_b64 v[242:243], v168 offset:1024
  ds_read_b64 v[244:245], v168 offset:512
  ds_read_b64 v[246:247], v168 offset:0
  s_barrier
  s_cmp_eq_u32 s15, 0
  s_cbranch_scc1 L16
  ds_write_b128 v25, v[176:179] offset:0
  ds_write_b128 v25, v[180:183] offset:1024
  ds_write_b128 v25, v[184:187] offset:2048
  ds_write_b128 v25, v[188:191] offset:3072
  v_mov_b64 v[176:177], v[192:193]
  v_mov_b64 v[178:179], v[194:195]
  v_mov_b64 v[180:181], v[196:197]
  v_mov_b64 v[182:183], v[198:199]
  v_mov_b64 v[184:185], v[200:201]
  v_mov_b64 v[186:187], v[202:203]
  v_mov_b64 v[188:189], v[204:205]
  v_mov_b64 v[190:191], v[206:207]
  s_branch L17
L16:
  s_nop 7
  ds_write_b128 v25, v[192:195] offset:0
  ds_write_b128 v25, v[196:199] offset:1024
  ds_write_b128 v25, v[200:203] offset:2048
  ds_write_b128 v25, v[204:207] offset:3072
L17:
  v_lshlrev_b32 v166, 16, v11
  v_lshlrev_b32 v167, 16, v11
  s_waitcnt lgkmcnt(4)
  v_and_b32 v224, 0xffff0000, v241
  v_lshlrev_b32 v225, 16, v241
  v_and_b32 v226, 0xffff0000, v240
  v_lshlrev_b32 v227, 16, v240
  v_and_b32 v228, 0xffff0000, v243
  v_lshlrev_b32 v229, 16, v243
  v_and_b32 v230, 0xffff0000, v242
  v_lshlrev_b32 v231, 16, v242
  v_and_b32 v232, 0xffff0000, v245
  v_lshlrev_b32 v233, 16, v245
  v_and_b32 v234, 0xffff0000, v244
  v_lshlrev_b32 v235, 16, v244
  v_and_b32 v236, 0xffff0000, v247
  v_lshlrev_b32 v237, 16, v247
  v_and_b32 v238, 0xffff0000, v246
  v_lshlrev_b32 v239, 16, v246
  s_waitcnt lgkmcnt(0)
  s_barrier
  ds_read_b128 v[208:211], v26 offset:0
  ds_read_b128 v[212:215], v26 offset:1024
  ds_read_b128 v[216:219], v26 offset:2048
  ds_read_b128 v[220:223], v26 offset:3072
  buffer_load_dwordx4 v[192:195], v10, s[32:35], s99 offen
  buffer_load_dwordx4 v[196:199], v10, s[32:35], s99 offen offset:64
  buffer_load_dwordx2 v[248:249], v160, s[76:79], s13 offen sc1
  buffer_load_ushort v29, v161, s[68:71], s14 offen
  s_waitcnt vmcnt(16)
  s_waitcnt lgkmcnt(0)
  v_mfma_f32_16x16x32_bf16 v[32:35], v[96:99], a[0:3], 0
  v_pk_mul_f32 v[224:225], v[224:225], v[166:167]
  v_pk_mul_f32 v[226:227], v[226:227], v[166:167]
  v_mfma_f32_16x16x32_bf16 v[48:51], v[96:99], a[4:7], 0
  v_pk_mul_f32 v[228:229], v[228:229], v[166:167]
  v_pk_mul_f32 v[230:231], v[230:231], v[166:167]
  v_mfma_f32_16x16x32_bf16 v[64:67], v[96:99], a[8:11], 0
  v_pk_mul_f32 v[232:233], v[232:233], v[166:167]
  v_pk_mul_f32 v[234:235], v[234:235], v[166:167]
  v_mfma_f32_16x16x32_bf16 v[80:83], v[96:99], a[12:15], 0
  buffer_load_dwordx4 v[96:99], v2, s[76:79], s16 offen offset:0 sc1
  v_pk_mul_f32 v[236:237], v[236:237], v[166:167]
  v_mfma_f32_16x16x32_bf16 v[36:39], v[100:103], a[0:3], 0
  v_pk_mul_f32 v[238:239], v[238:239], v[166:167]
  v_cvt_pk_bf16_f32 v224, 0, v224
  v_mfma_f32_16x16x32_bf16 v[52:55], v[100:103], a[4:7], 0
  v_cvt_pk_bf16_f32 v225, 0, v225
  v_cvt_pk_bf16_f32 v226, 0, v226
  v_mfma_f32_16x16x32_bf16 v[68:71], v[100:103], a[8:11], 0
  v_cvt_pk_bf16_f32 v227, 0, v227
  v_cvt_pk_bf16_f32 v228, 0, v228
  v_mfma_f32_16x16x32_bf16 v[84:87], v[100:103], a[12:15], 0
  buffer_load_dwordx4 v[100:103], v2, s[76:79], s16 offen offset:1024 sc1
  v_cvt_pk_bf16_f32 v229, 0, v229
  v_mfma_f32_16x16x32_bf16 v[40:43], v[104:107], a[0:3], 0
  v_cvt_pk_bf16_f32 v230, 0, v230
  v_cvt_pk_bf16_f32 v231, 0, v231
  v_mfma_f32_16x16x32_bf16 v[56:59], v[104:107], a[4:7], 0
  v_cvt_pk_bf16_f32 v232, 0, v232
  v_cvt_pk_bf16_f32 v233, 0, v233
  v_mfma_f32_16x16x32_bf16 v[72:75], v[104:107], a[8:11], 0
  v_cvt_pk_bf16_f32 v234, 0, v234
  v_cvt_pk_bf16_f32 v235, 0, v235
  v_mfma_f32_16x16x32_bf16 v[88:91], v[104:107], a[12:15], 0
  buffer_load_dwordx4 v[104:107], v2, s[76:79], s16 offen offset:2048 sc1
  v_cvt_pk_bf16_f32 v236, 0, v236
  v_mfma_f32_16x16x32_bf16 v[44:47], v[108:111], a[0:3], 0
  v_cvt_pk_bf16_f32 v237, 0, v237
  v_cvt_pk_bf16_f32 v238, 0, v238
  v_mfma_f32_16x16x32_bf16 v[60:63], v[108:111], a[4:7], 0
  v_cvt_pk_bf16_f32 v239, 0, v239
  s_waitcnt lgkmcnt(0)
  v_mfma_f32_16x16x32_bf16 v[76:79], v[108:111], a[8:11], 0
  v_pk_add_f32 v[176:177], v[176:177], v[208:209]
  v_pk_add_f32 v[178:179], v[178:179], v[210:211]
  v_mfma_f32_16x16x32_bf16 v[92:95], v[108:111], a[12:15], 0
  buffer_load_dwordx4 v[108:111], v2, s[76:79], s16 offen offset:3072 sc1
  s_add_u32 s16, s16, 4096
  s_waitcnt vmcnt(16)
  v_mfma_f32_16x16x32_bf16 v[32:35], v[112:115], a[16:19], v[32:35]
  v_pk_add_f32 v[180:181], v[180:181], v[212:213]
  v_pk_add_f32 v[182:183], v[182:183], v[214:215]
  v_mfma_f32_16x16x32_bf16 v[48:51], v[112:115], a[20:23], v[48:51]
  v_pk_add_f32 v[184:185], v[184:185], v[216:217]
  v_pk_add_f32 v[186:187], v[186:187], v[218:219]
  v_mfma_f32_16x16x32_bf16 v[64:67], v[112:115], a[24:27], v[64:67]
  v_pk_add_f32 v[188:189], v[188:189], v[220:221]
  v_pk_add_f32 v[190:191], v[190:191], v[222:223]
  v_mfma_f32_16x16x32_bf16 v[80:83], v[112:115], a[28:31], v[80:83]
  buffer_load_dwordx4 v[112:115], v2, s[76:79], s16 offen offset:0 sc1
  v_cvt_pk_bf16_f32 v176, 0, v176
  v_mfma_f32_16x16x32_bf16 v[36:39], v[116:119], a[16:19], v[36:39]
  v_cvt_pk_bf16_f32 v177, 0, v177
  v_cvt_pk_bf16_f32 v178, 0, v178
  v_mfma_f32_16x16x32_bf16 v[52:55], v[116:119], a[20:23], v[52:55]
  v_cvt_pk_bf16_f32 v179, 0, v179
  v_cvt_pk_bf16_f32 v180, 0, v180
  v_mfma_f32_16x16x32_bf16 v[68:71], v[116:119], a[24:27], v[68:71]
  v_cvt_pk_bf16_f32 v181, 0, v181
  v_cvt_pk_bf16_f32 v182, 0, v182
  v_mfma_f32_16x16x32_bf16 v[84:87], v[116:119], a[28:31], v[84:87]
  buffer_load_dwordx4 v[116:119], v2, s[76:79], s16 offen offset:1024 sc1
  v_cvt_pk_bf16_f32 v183, 0, v183
  v_mfma_f32_16x16x32_bf16 v[40:43], v[120:123], a[16:19], v[40:43]
  v_cvt_pk_bf16_f32 v184, 0, v184
  v_cvt_pk_bf16_f32 v185, 0, v185
  v_mfma_f32_16x16x32_bf16 v[56:59], v[120:123], a[20:23], v[56:59]
  v_cvt_pk_bf16_f32 v186, 0, v186
  v_cvt_pk_bf16_f32 v187, 0, v187
  v_mfma_f32_16x16x32_bf16 v[72:75], v[120:123], a[24:27], v[72:75]
  v_cvt_pk_bf16_f32 v188, 0, v188
  v_cvt_pk_bf16_f32 v189, 0, v189
  v_mfma_f32_16x16x32_bf16 v[88:91], v[120:123], a[28:31], v[88:91]
  buffer_load_dwordx4 v[120:123], v2, s[76:79], s16 offen offset:2048 sc1
  v_cvt_pk_bf16_f32 v190, 0, v190
  v_mfma_f32_16x16x32_bf16 v[44:47], v[124:127], a[16:19], v[44:47]
  v_cvt_pk_bf16_f32 v191, 0, v191
  v_pk_add_f32 v[176:177], v[176:177], v[224:225]
  v_mfma_f32_16x16x32_bf16 v[60:63], v[124:127], a[20:23], v[60:63]
  v_pk_add_f32 v[178:179], v[178:179], v[226:227]
  v_pk_add_f32 v[180:181], v[180:181], v[228:229]
  v_mfma_f32_16x16x32_bf16 v[76:79], v[124:127], a[24:27], v[76:79]
  v_pk_add_f32 v[182:183], v[182:183], v[230:231]
  v_pk_add_f32 v[184:185], v[184:185], v[232:233]
  v_mfma_f32_16x16x32_bf16 v[92:95], v[124:127], a[28:31], v[92:95]
  buffer_load_dwordx4 v[124:127], v2, s[76:79], s16 offen offset:3072 sc1
  s_add_u32 s16, s16, 4096
  s_cmp_eq_u32 s16, s3
  s_cselect_b32 s100, 57344, 0
  s_sub_u32 s16, s16, s100
  s_waitcnt vmcnt(16)
  v_mfma_f32_16x16x32_bf16 v[32:35], v[128:131], a[32:35], v[32:35]
  v_pk_add_f32 v[186:187], v[186:187], v[234:235]
  v_pk_add_f32 v[188:189], v[188:189], v[236:237]
  v_mfma_f32_16x16x32_bf16 v[48:51], v[128:131], a[36:39], v[48:51]
  v_pk_add_f32 v[190:191], v[190:191], v[238:239]
  v_cvt_pk_bf16_f32 v240, v176, v177
  v_mfma_f32_16x16x32_bf16 v[64:67], v[128:131], a[40:43], v[64:67]
  v_cvt_pk_bf16_f32 v241, v178, v179
  v_cvt_pk_bf16_f32 v242, v180, v181
  v_mfma_f32_16x16x32_bf16 v[80:83], v[128:131], a[44:47], v[80:83]
  buffer_load_dwordx4 v[128:131], v2, s[76:79], s16 offen offset:0 sc1
  v_cvt_pk_bf16_f32 v243, v182, v183
  v_mfma_f32_16x16x32_bf16 v[36:39], v[132:135], a[32:35], v[36:39]
  v_cvt_pk_bf16_f32 v244, v184, v185
  v_cvt_pk_bf16_f32 v245, v186, v187
  v_mfma_f32_16x16x32_bf16 v[52:55], v[132:135], a[36:39], v[52:55]
  v_cvt_pk_bf16_f32 v246, v188, v189
  v_cvt_pk_bf16_f32 v247, v190, v191
  v_mfma_f32_16x16x32_bf16 v[68:71], v[132:135], a[40:43], v[68:71]
  v_permlane16_swap_b32 v240, v242
  v_permlane16_swap_b32 v241, v243
  v_mfma_f32_16x16x32_bf16 v[84:87], v[132:135], a[44:47], v[84:87]
  buffer_load_dwordx4 v[132:135], v2, s[76:79], s16 offen offset:1024 sc1
  v_permlane16_swap_b32 v244, v246
  v_mfma_f32_16x16x32_bf16 v[40:43], v[136:139], a[32:35], v[40:43]
  v_permlane16_swap_b32 v245, v247
  v_mfma_f32_16x16x32_bf16 v[56:59], v[136:139], a[36:39], v[56:59]
  buffer_store_dwordx4 v[240:243], v27, s[76:79], s12 offen offset:0 sc1
  v_mfma_f32_16x16x32_bf16 v[72:75], v[136:139], a[40:43], v[72:75]
  v_mfma_f32_16x16x32_bf16 v[88:91], v[136:139], a[44:47], v[88:91]
  buffer_load_dwordx4 v[136:139], v2, s[76:79], s16 offen offset:2048 sc1
  v_mfma_f32_16x16x32_bf16 v[44:47], v[140:143], a[32:35], v[44:47]
  v_mfma_f32_16x16x32_bf16 v[60:63], v[140:143], a[36:39], v[60:63]
  buffer_store_dwordx4 v[244:247], v27, s[76:79], s12 offen offset:1024 sc1
  v_mfma_f32_16x16x32_bf16 v[76:79], v[140:143], a[40:43], v[76:79]
  ds_read_b64_tr_b16 a[160:161], v5 offset:16384
  ds_read_b64_tr_b16 a[162:163], v5 offset:16896
  v_mfma_f32_16x16x32_bf16 v[92:95], v[140:143], a[44:47], v[92:95]
  buffer_load_dwordx4 v[140:143], v2, s[76:79], s16 offen offset:3072 sc1
  s_add_u32 s16, s16, 4096
  s_waitcnt vmcnt(18)
  v_mfma_f32_16x16x32_bf16 v[32:35], v[144:147], a[48:51], v[32:35]
  ds_read_b64_tr_b16 a[164:165], v6 offset:16384
  ds_read_b64_tr_b16 a[166:167], v6 offset:16896
  v_mfma_f32_16x16x32_bf16 v[48:51], v[144:147], a[52:55], v[48:51]
  ds_read_b64_tr_b16 a[168:169], v7 offset:16384
  ds_read_b64_tr_b16 a[170:171], v7 offset:16896
  v_mfma_f32_16x16x32_bf16 v[64:67], v[144:147], a[56:59], v[64:67]
  ds_read_b64_tr_b16 a[172:173], v8 offset:16384
  ds_read_b64_tr_b16 a[174:175], v8 offset:16896
  v_mfma_f32_16x16x32_bf16 v[80:83], v[144:147], a[60:63], v[80:83]
  buffer_load_dwordx4 v[144:147], v2, s[76:79], s16 offen offset:0 sc1
  ds_read_b64_tr_b16 a[176:177], v5 offset:20480
  v_mfma_f32_16x16x32_bf16 v[36:39], v[148:151], a[48:51], v[36:39]
  ds_read_b64_tr_b16 a[178:179], v5 offset:20992
  ds_read_b64_tr_b16 a[180:181], v6 offset:20480
  v_mfma_f32_16x16x32_bf16 v[52:55], v[148:151], a[52:55], v[52:55]
  ds_read_b64_tr_b16 a[182:183], v6 offset:20992
  ds_read_b64_tr_b16 a[184:185], v7 offset:20480
  v_mfma_f32_16x16x32_bf16 v[68:71], v[148:151], a[56:59], v[68:71]
  ds_read_b64_tr_b16 a[186:187], v7 offset:20992
  ds_read_b64_tr_b16 a[188:189], v8 offset:20480
  v_mfma_f32_16x16x32_bf16 v[84:87], v[148:151], a[60:63], v[84:87]
  buffer_load_dwordx4 v[148:151], v2, s[76:79], s16 offen offset:1024 sc1
  ds_read_b64_tr_b16 a[190:191], v8 offset:20992
  v_mfma_f32_16x16x32_bf16 v[40:43], v[152:155], a[48:51], v[40:43]
  ds_read_b64_tr_b16 a[192:193], v5 offset:0
  ds_read_b64_tr_b16 a[194:195], v5 offset:512
  v_mfma_f32_16x16x32_bf16 v[56:59], v[152:155], a[52:55], v[56:59]
  ds_read_b64_tr_b16 a[196:197], v6 offset:0
  ds_read_b64_tr_b16 a[198:199], v6 offset:512
  v_mfma_f32_16x16x32_bf16 v[72:75], v[152:155], a[56:59], v[72:75]
  ds_read_b64_tr_b16 a[200:201], v7 offset:0
  ds_read_b64_tr_b16 a[202:203], v7 offset:512
  v_mfma_f32_16x16x32_bf16 v[88:91], v[152:155], a[60:63], v[88:91]
  buffer_load_dwordx4 v[152:155], v2, s[76:79], s16 offen offset:2048 sc1
  ds_read_b64_tr_b16 a[204:205], v8 offset:0
  v_mfma_f32_16x16x32_bf16 v[44:47], v[156:159], a[48:51], v[44:47]
  ds_read_b64_tr_b16 a[206:207], v8 offset:512
  ds_read_b64_tr_b16 a[208:209], v5 offset:4096
  v_mfma_f32_16x16x32_bf16 v[60:63], v[156:159], a[52:55], v[60:63]
  ds_read_b64_tr_b16 a[210:211], v5 offset:4608
  ds_read_b64_tr_b16 a[212:213], v6 offset:4096
  v_mfma_f32_16x16x32_bf16 v[76:79], v[156:159], a[56:59], v[76:79]
  ds_read_b64_tr_b16 a[214:215], v6 offset:4608
  ds_read_b64_tr_b16 a[216:217], v7 offset:4096
  v_mfma_f32_16x16x32_bf16 v[92:95], v[156:159], a[60:63], v[92:95]
  buffer_load_dwordx4 v[156:159], v2, s[76:79], s16 offen offset:3072 sc1
  s_add_u32 s16, s16, 4096
  s_cmp_eq_u32 s16, s3
  s_cselect_b32 s100, 57344, 0
  s_sub_u32 s16, s16, s100
  s_waitcnt vmcnt(14)
  s_waitcnt lgkmcnt(0)
  v_mfma_f32_16x16x32_bf16 v[32:35], v[96:99], a[64:67], v[32:35]
  v_mfma_f32_16x16x32_bf16 v[48:51], v[96:99], a[68:71], v[48:51]
  s_waitcnt vmcnt(18)
  v_xor_b32 v252, 0x80000000, v248
  v_mfma_f32_16x16x32_bf16 v[64:67], v[96:99], a[72:75], v[64:67]
  v_xor_b32 v253, 0x80000000, v248
  v_mov_b32 v248, v249
  v_mfma_f32_16x16x32_bf16 v[80:83], v[96:99], a[76:79], v[80:83]
  buffer_load_dwordx4 v[96:99], v2, s[76:79], s16 offen offset:0 sc1
  v_lshlrev_b32 v224, 16, v192
  v_mfma_f32_16x16x32_bf16 v[36:39], v[100:103], a[64:67], v[36:39]
  v_and_b32 v225, 0xffff0000, v192
  v_lshlrev_b32 v226, 16, v193
  v_mfma_f32_16x16x32_bf16 v[52:55], v[100:103], a[68:71], v[52:55]
  v_and_b32 v227, 0xffff0000, v193
  v_lshlrev_b32 v228, 16, v194
  v_mfma_f32_16x16x32_bf16 v[68:71], v[100:103], a[72:75], v[68:71]
  v_and_b32 v229, 0xffff0000, v194
  v_lshlrev_b32 v230, 16, v195
  v_mfma_f32_16x16x32_bf16 v[84:87], v[100:103], a[76:79], v[84:87]
  buffer_load_dwordx4 v[100:103], v2, s[76:79], s16 offen offset:1024 sc1
  v_and_b32 v231, 0xffff0000, v195
  v_mfma_f32_16x16x32_bf16 v[40:43], v[104:107], a[64:67], v[40:43]
  v_lshlrev_b32 v232, 16, v196
  v_and_b32 v233, 0xffff0000, v196
  v_mfma_f32_16x16x32_bf16 v[56:59], v[104:107], a[68:71], v[56:59]
  v_lshlrev_b32 v234, 16, v197
  v_and_b32 v235, 0xffff0000, v197
  v_mfma_f32_16x16x32_bf16 v[72:75], v[104:107], a[72:75], v[72:75]
  v_lshlrev_b32 v236, 16, v198
  v_and_b32 v237, 0xffff0000, v198
  v_mfma_f32_16x16x32_bf16 v[88:91], v[104:107], a[76:79], v[88:91]
  buffer_load_dwordx4 v[104:107], v2, s[76:79], s16 offen offset:2048 sc1
  v_lshlrev_b32 v238, 16, v199
  v_mfma_f32_16x16x32_bf16 v[44:47], v[108:111], a[64:67], v[44:47]
  v_and_b32 v239, 0xffff0000, v199
  v_pk_add_f32 v[208:209], v[224:225], v[252:253]
  v_mfma_f32_16x16x32_bf16 v[60:63], v[108:111], a[68:71], v[60:63]
  v_pk_add_f32 v[210:211], v[226:227], v[252:253]
  v_pk_add_f32 v[212:213], v[228:229], v[252:253]
  v_mfma_f32_16x16x32_bf16 v[76:79], v[108:111], a[72:75], v[76:79]
  v_pk_add_f32 v[214:215], v[230:231], v[252:253]
  v_pk_add_f32 v[216:217], v[232:233], v[252:253]
  v_mfma_f32_16x16x32_bf16 v[92:95], v[108:111], a[76:79], v[92:95]
  buffer_load_dwordx4 v[108:111], v2, s[76:79], s16 offen offset:3072 sc1
  s_add_u32 s16, s16, 4096
  s_waitcnt vmcnt(14)
  v_mfma_f32_16x16x32_bf16 v[32:35], v[112:115], a[80:83], v[32:35]
  v_pk_add_f32 v[218:219], v[234:235], v[252:253]
  v_pk_add_f32 v[220:221], v[236:237], v[252:253]
  v_mfma_f32_16x16x32_bf16 v[48:51], v[112:115], a[84:87], v[48:51]
  v_pk_add_f32 v[222:223], v[238:239], v[252:253]
  v_cvt_pk_bf16_f32 v208, 0, v208
  v_mfma_f32_16x16x32_bf16 v[64:67], v[112:115], a[88:91], v[64:67]
  v_cvt_pk_bf16_f32 v209, 0, v209
  v_cvt_pk_bf16_f32 v210, 0, v210
  v_mfma_f32_16x16x32_bf16 v[80:83], v[112:115], a[92:95], v[80:83]
  buffer_load_dwordx4 v[112:115], v2, s[76:79], s16 offen offset:0 sc1
  v_cvt_pk_bf16_f32 v211, 0, v211
  v_mfma_f32_16x16x32_bf16 v[36:39], v[116:119], a[80:83], v[36:39]
  v_cvt_pk_bf16_f32 v212, 0, v212
  v_cvt_pk_bf16_f32 v213, 0, v213
  v_mfma_f32_16x16x32_bf16 v[52:55], v[116:119], a[84:87], v[52:55]
  v_cvt_pk_bf16_f32 v214, 0, v214
  v_cvt_pk_bf16_f32 v215, 0, v215
  v_mfma_f32_16x16x32_bf16 v[68:71], v[116:119], a[88:91], v[68:71]
  v_cvt_pk_bf16_f32 v216, 0, v216
  v_cvt_pk_bf16_f32 v217, 0, v217
  v_mfma_f32_16x16x32_bf16 v[84:87], v[116:119], a[92:95], v[84:87]
  buffer_load_dwordx4 v[116:119], v2, s[76:79], s16 offen offset:1024 sc1
  v_cvt_pk_bf16_f32 v218, 0, v218
  v_mfma_f32_16x16x32_bf16 v[40:43], v[120:123], a[80:83], v[40:43]
  v_cvt_pk_bf16_f32 v219, 0, v219
  v_cvt_pk_bf16_f32 v220, 0, v220
  v_mfma_f32_16x16x32_bf16 v[56:59], v[120:123], a[84:87], v[56:59]
  v_cvt_pk_bf16_f32 v221, 0, v221
  v_cvt_pk_bf16_f32 v222, 0, v222
  v_mfma_f32_16x16x32_bf16 v[72:75], v[120:123], a[88:91], v[72:75]
  v_cvt_pk_bf16_f32 v223, 0, v223
  v_pk_mul_f32 v[208:209], v[208:209], v[248:249]
  v_mfma_f32_16x16x32_bf16 v[88:91], v[120:123], a[92:95], v[88:91]
  buffer_load_dwordx4 v[120:123], v2, s[76:79], s16 offen offset:2048 sc1
  v_pk_mul_f32 v[210:211], v[210:211], v[248:249]
  v_mfma_f32_16x16x32_bf16 v[44:47], v[124:127], a[80:83], v[44:47]
  v_pk_mul_f32 v[212:213], v[212:213], v[248:249]
  v_pk_mul_f32 v[214:215], v[214:215], v[248:249]
  v_mfma_f32_16x16x32_bf16 v[60:63], v[124:127], a[84:87], v[60:63]
  v_pk_mul_f32 v[216:217], v[216:217], v[248:249]
  v_pk_mul_f32 v[218:219], v[218:219], v[248:249]
  v_mfma_f32_16x16x32_bf16 v[76:79], v[124:127], a[88:91], v[76:79]
  v_pk_mul_f32 v[220:221], v[220:221], v[248:249]
  v_pk_mul_f32 v[222:223], v[222:223], v[248:249]
  v_mfma_f32_16x16x32_bf16 v[92:95], v[124:127], a[92:95], v[92:95]
  buffer_load_dwordx4 v[124:127], v2, s[76:79], s16 offen offset:3072 sc1
  s_add_u32 s16, s16, 4096
  s_cmp_eq_u32 s16, s3
  s_cselect_b32 s100, 57344, 0
  s_sub_u32 s16, s16, s100
  s_waitcnt vmcnt(12)
  s_lshl_b32 s8, s83, 5
  s_add_u32 s8, s8, s84
  s_mul_i32 s8, s8, 16
  s_add_u32 s8, s8, 8650752
  s_cmp_eq_u32 s80, 0
  s_cselect_b32 s8, s8, 1073741824
  v_mov_b32 v30, s85
  v_mov_b32 v31, 0
  s_barrier
  s_mov_b64 exec, 1
  buffer_store_dword v30, v31, s[76:79], s8 offen sc1
  s_mov_b64 exec, -1
  v_mfma_f32_16x16x32_bf16 v[32:35], v[128:131], a[96:99], v[32:35]
  v_cvt_pk_bf16_f32 v208, 0, v208
  v_cvt_pk_bf16_f32 v209, 0, v209
  v_mfma_f32_16x16x32_bf16 v[48:51], v[128:131], a[100:103], v[48:51]
  v_cvt_pk_bf16_f32 v210, 0, v210
  v_cvt_pk_bf16_f32 v211, 0, v211
  v_mfma_f32_16x16x32_bf16 v[64:67], v[128:131], a[104:107], v[64:67]
  v_cvt_pk_bf16_f32 v212, 0, v212
  v_cvt_pk_bf16_f32 v213, 0, v213
  v_mfma_f32_16x16x32_bf16 v[80:83], v[128:131], a[108:111], v[80:83]
  buffer_load_dwordx4 v[128:131], v2, s[76:79], s16 offen offset:0 sc1
  v_cvt_pk_bf16_f32 v214, 0, v214
  v_mfma_f32_16x16x32_bf16 v[36:39], v[132:135], a[96:99], v[36:39]
  v_cvt_pk_bf16_f32 v215, 0, v215
  v_cvt_pk_bf16_f32 v216, 0, v216
  v_mfma_f32_16x16x32_bf16 v[52:55], v[132:135], a[100:103], v[52:55]
  v_cvt_pk_bf16_f32 v217, 0, v217
  v_cvt_pk_bf16_f32 v218, 0, v218
  v_mfma_f32_16x16x32_bf16 v[68:71], v[132:135], a[104:107], v[68:71]
  v_cvt_pk_bf16_f32 v219, 0, v219
  v_cvt_pk_bf16_f32 v220, 0, v220
  v_mfma_f32_16x16x32_bf16 v[84:87], v[132:135], a[108:111], v[84:87]
  buffer_load_dwordx4 v[132:135], v2, s[76:79], s16 offen offset:1024 sc1
  v_cvt_pk_bf16_f32 v221, 0, v221
  v_mfma_f32_16x16x32_bf16 v[40:43], v[136:139], a[96:99], v[40:43]
  v_cvt_pk_bf16_f32 v222, 0, v222
  v_cvt_pk_bf16_f32 v223, 0, v223
  v_mfma_f32_16x16x32_bf16 v[56:59], v[136:139], a[100:103], v[56:59]
  v_lshlrev_b32 v28, 16, v29
  v_mov_b32 v20, 0xbfb8aa3b
  v_mfma_f32_16x16x32_bf16 v[72:75], v[136:139], a[104:107], v[72:75]
  v_mov_b64 v[176:177], 0
  v_mov_b64 v[178:179], 0
  v_mfma_f32_16x16x32_bf16 v[88:91], v[136:139], a[108:111], v[88:91]
  buffer_load_dwordx4 v[136:139], v2, s[76:79], s16 offen offset:2048 sc1
  v_mov_b64 v[180:181], 0
  v_mfma_f32_16x16x32_bf16 v[44:47], v[140:143], a[96:99], v[44:47]
  v_mov_b64 v[182:183], 0
  v_mov_b64 v[184:185], 0
  v_mfma_f32_16x16x32_bf16 v[60:63], v[140:143], a[100:103], v[60:63]
  v_mov_b64 v[186:187], 0
  v_mov_b64 v[188:189], 0
  v_mfma_f32_16x16x32_bf16 v[76:79], v[140:143], a[104:107], v[76:79]
  v_mov_b64 v[190:191], 0
  v_mfma_f32_16x16x32_bf16 v[92:95], v[140:143], a[108:111], v[92:95]
  buffer_load_dwordx4 v[140:143], v2, s[76:79], s16 offen offset:3072 sc1
  s_add_u32 s16, s16, 4096
  s_waitcnt vmcnt(13)
  v_mfma_f32_16x16x32_bf16 v[32:35], v[144:147], a[112:115], v[32:35]
  ds_read_b64_tr_b16 a[218:219], v7 offset:4608
  ds_read_b64_tr_b16 a[220:221], v8 offset:4096
  v_mfma_f32_16x16x32_bf16 v[48:51], v[144:147], a[116:119], v[48:51]
  ds_read_b64_tr_b16 a[222:223], v8 offset:4608
  v_mfma_f32_16x16x32_bf16 v[64:67], v[144:147], a[120:123], v[64:67]
  v_mfma_f32_16x16x32_bf16 v[80:83], v[144:147], a[124:127], v[80:83]
  buffer_load_dwordx4 v[144:147], v2, s[76:79], s16 offen offset:0 sc1
  v_mfma_f32_16x16x32_bf16 v[36:39], v[148:151], a[112:115], v[36:39]
  v_mfma_f32_16x16x32_bf16 v[52:55], v[148:151], a[116:119], v[52:55]
  v_mfma_f32_16x16x32_bf16 v[68:71], v[148:151], a[120:123], v[68:71]
  v_mfma_f32_16x16x32_bf16 v[84:87], v[148:151], a[124:127], v[84:87]
  buffer_load_dwordx4 v[148:151], v2, s[76:79], s16 offen offset:1024 sc1
  v_mfma_f32_16x16x32_bf16 v[40:43], v[152:155], a[112:115], v[40:43]
  v_mfma_f32_16x16x32_bf16 v[56:59], v[152:155], a[116:119], v[56:59]
  v_mfma_f32_16x16x32_bf16 v[72:75], v[152:155], a[120:123], v[72:75]
  v_mfma_f32_16x16x32_bf16 v[88:91], v[152:155], a[124:127], v[88:91]
  buffer_load_dwordx4 v[152:155], v2, s[76:79], s16 offen offset:2048 sc1
  v_mfma_f32_16x16x32_bf16 v[44:47], v[156:159], a[112:115], v[44:47]
  v_mfma_f32_16x16x32_bf16 v[60:63], v[156:159], a[116:119], v[60:63]
  v_mfma_f32_16x16x32_bf16 v[76:79], v[156:159], a[120:123], v[76:79]
  v_mfma_f32_16x16x32_bf16 v[92:95], v[156:159], a[124:127], v[92:95]
  buffer_load_dwordx4 v[156:159], v2, s[76:79], s16 offen offset:3072 sc1
  s_add_u32 s16, s16, 4096
  s_cmp_eq_u32 s16, s3
  s_cselect_b32 s100, 57344, 0
  s_sub_u32 s16, s16, s100
  s_waitcnt vmcnt(13)
  s_waitcnt lgkmcnt(0)
  v_mfma_f32_16x16x32_bf16 v[32:35], v[96:99], a[128:131], v[32:35]
  v_mfma_f32_16x16x32_bf16 v[48:51], v[96:99], a[132:135], v[48:51]
  v_mfma_f32_16x16x32_bf16 v[64:67], v[96:99], a[136:139], v[64:67]
  v_mfma_f32_16x16x32_bf16 v[80:83], v[96:99], a[140:143], v[80:83]
  buffer_load_dwordx4 v[96:99], v2, s[76:79], s16 offen offset:0 sc1
  v_mfma_f32_16x16x32_bf16 v[36:39], v[100:103], a[128:131], v[36:39]
  v_mfma_f32_16x16x32_bf16 v[52:55], v[100:103], a[132:135], v[52:55]
  v_mfma_f32_16x16x32_bf16 v[68:71], v[100:103], a[136:139], v[68:71]
  v_mfma_f32_16x16x32_bf16 v[84:87], v[100:103], a[140:143], v[84:87]
  buffer_load_dwordx4 v[100:103], v2, s[76:79], s16 offen offset:1024 sc1
  v_mfma_f32_16x16x32_bf16 v[40:43], v[104:107], a[128:131], v[40:43]
  v_mfma_f32_16x16x32_bf16 v[56:59], v[104:107], a[132:135], v[56:59]
  v_mfma_f32_16x16x32_bf16 v[72:75], v[104:107], a[136:139], v[72:75]
  v_mfma_f32_16x16x32_bf16 v[88:91], v[104:107], a[140:143], v[88:91]
  buffer_load_dwordx4 v[104:107], v2, s[76:79], s16 offen offset:2048 sc1
  v_mfma_f32_16x16x32_bf16 v[44:47], v[108:111], a[128:131], v[44:47]
  v_mfma_f32_16x16x32_bf16 v[60:63], v[108:111], a[132:135], v[60:63]
  v_mfma_f32_16x16x32_bf16 v[76:79], v[108:111], a[136:139], v[76:79]
  v_mfma_f32_16x16x32_bf16 v[92:95], v[108:111], a[140:143], v[92:95]
  buffer_load_dwordx4 v[108:111], v2, s[76:79], s16 offen offset:3072 sc1
  s_add_u32 s16, s16, 4096
  s_barrier
  s_waitcnt vmcnt(13)
  v_mfma_f32_16x16x32_bf16 v[32:35], v[112:115], a[144:147], v[32:35]
  v_mfma_f32_16x16x32_bf16 v[48:51], v[112:115], a[148:151], v[48:51]
  v_mfma_f32_16x16x32_bf16 v[64:67], v[112:115], a[152:155], v[64:67]
  v_mfma_f32_16x16x32_bf16 v[80:83], v[112:115], a[156:159], v[80:83]
  buffer_load_dwordx4 v[112:115], v2, s[76:79], s16 offen offset:0 sc1
  v_mfma_f32_16x16x32_bf16 v[36:39], v[116:119], a[144:147], v[36:39]
  v_mfma_f32_16x16x32_bf16 v[52:55], v[116:119], a[148:151], v[52:55]
  v_mfma_f32_16x16x32_bf16 v[68:71], v[116:119], a[152:155], v[68:71]
  v_mfma_f32_16x16x32_bf16 v[84:87], v[116:119], a[156:159], v[84:87]
  buffer_load_dwordx4 v[116:119], v2, s[76:79], s16 offen offset:1024 sc1
  v_mfma_f32_16x16x32_bf16 v[40:43], v[120:123], a[144:147], v[40:43]
  v_mfma_f32_16x16x32_bf16 v[56:59], v[120:123], a[148:151], v[56:59]
  v_mfma_f32_16x16x32_bf16 v[72:75], v[120:123], a[152:155], v[72:75]
  v_mfma_f32_16x16x32_bf16 v[88:91], v[120:123], a[156:159], v[88:91]
  buffer_load_dwordx4 v[120:123], v2, s[76:79], s16 offen offset:2048 sc1
  v_mfma_f32_16x16x32_bf16 v[44:47], v[124:127], a[144:147], v[44:47]
  v_mfma_f32_16x16x32_bf16 v[60:63], v[124:127], a[148:151], v[60:63]
  v_mfma_f32_16x16x32_bf16 v[76:79], v[124:127], a[152:155], v[76:79]
  v_mfma_f32_16x16x32_bf16 v[92:95], v[124:127], a[156:159], v[92:95]
  buffer_load_dwordx4 v[124:127], v2, s[76:79], s16 offen offset:3072 sc1
  s_add_u32 s16, s16, 4096
  s_cmp_eq_u32 s16, s3
  s_cselect_b32 s100, 57344, 0
  s_sub_u32 s16, s16, s100
  s_lshl_b32 s8, s83, 5
  s_mul_i32 s10, s8, 16
  s_add_u32 s10, s10, 8650752
  v_min_u32 v30, 31, v1
  v_mul_u32_u24 v30, 16, v30
  buffer_load_dword v31, v30, s[76:79], s10 offen sc1
  s_waitcnt vmcnt(13)
  v_mfma_f32_16x16x32_bf16 v[32:35], v[128:131], a[160:163], v[32:35]
  v_mfma_f32_16x16x32_bf16 v[48:51], v[128:131], a[164:167], v[48:51]
  v_mfma_f32_16x16x32_bf16 v[64:67], v[128:131], a[168:171], v[64:67]
  v_mfma_f32_16x16x32_bf16 v[80:83], v[128:131], a[172:175], v[80:83]
  v_mfma_f32_16x16x32_bf16 v[36:39], v[132:135], a[160:163], v[36:39]
  v_mfma_f32_16x16x32_bf16 v[52:55], v[132:135], a[164:167], v[52:55]
  v_mfma_f32_16x16x32_bf16 v[68:71], v[132:135], a[168:171], v[68:71]
  v_mfma_f32_16x16x32_bf16 v[84:87], v[132:135], a[172:175], v[84:87]
  v_mfma_f32_16x16x32_bf16 v[40:43], v[136:139], a[160:163], v[40:43]
  v_mfma_f32_16x16x32_bf16 v[56:59], v[136:139], a[164:167], v[56:59]
  v_mfma_f32_16x16x32_bf16 v[72:75], v[136:139], a[168:171], v[72:75]
  v_mfma_f32_16x16x32_bf16 v[88:91], v[136:139], a[172:175], v[88:91]
  v_mfma_f32_16x16x32_bf16 v[44:47], v[140:143], a[160:163], v[44:47]
  v_mfma_f32_16x16x32_bf16 v[60:63], v[140:143], a[164:167], v[60:63]
  v_mfma_f32_16x16x32_bf16 v[76:79], v[140:143], a[168:171], v[76:79]
  v_mfma_f32_16x16x32_bf16 v[92:95], v[140:143], a[172:175], v[92:95]
  s_waitcnt vmcnt(9)
  v_mfma_f32_16x16x32_bf16 v[32:35], v[144:147], a[176:179], v[32:35]
  v_mfma_f32_16x16x32_bf16 v[36:39], v[148:151], a[176:179], v[36:39]
  v_mfma_f32_16x16x32_bf16 v[40:43], v[152:155], a[176:179], v[40:43]
  v_mfma_f32_16x16x32_bf16 v[44:47], v[156:159], a[176:179], v[44:47]
  s_waitcnt vmcnt(5)
  v_mfma_f32_16x16x32_bf16 v[32:35], v[96:99], a[192:195], v[32:35]
  v_mfma_f32_16x16x32_bf16 v[36:39], v[100:103], a[192:195], v[36:39]
  v_mfma_f32_16x16x32_bf16 v[40:43], v[104:107], a[192:195], v[40:43]
  v_mfma_f32_16x16x32_bf16 v[44:47], v[108:111], a[192:195], v[44:47]
  s_waitcnt vmcnt(1)
  v_mfma_f32_16x16x32_bf16 v[32:35], v[112:115], a[208:211], v[32:35]
  v_mfma_f32_16x16x32_bf16 v[36:39], v[116:119], a[208:211], v[36:39]
  v_mfma_f32_16x16x32_bf16 v[40:43], v[120:123], a[208:211], v[40:43]
  v_mfma_f32_16x16x32_bf16 v[44:47], v[124:127], a[208:211], v[44:47]
  v_mfma_f32_16x16x32_bf16 v[48:51], v[144:147], a[180:183], v[48:51]
  s_waitcnt vmcnt(0)
  s_mov_b32 s9, 0
P18:
  v_cmp_ne_u32 vcc, s85, v31
  s_nop 4
  s_cbranch_vccz Q19
  s_sleep 4
  buffer_load_dword v31, v30, s[76:79], s10 offen sc1
  s_add_u32 s9, s9, 1
  s_cmp_lt_u32 s9, 0x40000
  s_waitcnt vmcnt(0)
  s_cbranch_scc1 P18
Q19:
  s_mul_i32 s12, s83, 262144
  s_add_u32 s12, s12, s14
  s_add_u32 s12, s12, 6291456
  v_mfma_f32_16x16x32_bf16 v[52:55], v[148:151], a[180:183], v[52:55]
  v_mfma_f32_16x16x32_bf16 v[56:59], v[152:155], a[180:183], v[56:59]
  ds_write_b128 v12, v[32:35] offset:0
  buffer_load_short_d16_hi v176, v4, s[76:79], s12 offen sc1
  s_add_u32 s12, s12, 4096
  v_mfma_f32_16x16x32_bf16 v[60:63], v[156:159], a[180:183], v[60:63]
  v_mfma_f32_16x16x32_bf16 v[48:51], v[96:99], a[196:199], v[48:51]
  ds_write_b128 v12, v[36:39] offset:1024
  buffer_load_short_d16_hi v177, v4, s[76:79], s12 offen sc1
  s_add_u32 s12, s12, 4096
  v_mfma_f32_16x16x32_bf16 v[52:55], v[100:103], a[196:199], v[52:55]
  v_mfma_f32_16x16x32_bf16 v[56:59], v[104:107], a[196:199], v[56:59]
  ds_write_b128 v12, v[40:43] offset:2048
  buffer_load_short_d16_hi v178, v4, s[76:79], s12 offen sc1
  s_add_u32 s12, s12, 4096
  v_mfma_f32_16x16x32_bf16 v[60:63], v[108:111], a[196:199], v[60:63]
  v_mfma_f32_16x16x32_bf16 v[48:51], v[112:115], a[212:215], v[48:51]
  ds_write_b128 v12, v[44:47] offset:3072
  buffer_load_short_d16_hi v179, v4, s[76:79], s12 offen sc1
  s_add_u32 s12, s12, 4096
  v_mfma_f32_16x16x32_bf16 v[52:55], v[116:119], a[212:215], v[52:55]
  v_mfma_f32_16x16x32_bf16 v[56:59], v[120:123], a[212:215], v[56:59]
  buffer_load_short_d16_hi v180, v4, s[76:79], s12 offen sc1
  s_add_u32 s12, s12, 4096
  v_mfma_f32_16x16x32_bf16 v[60:63], v[124:127], a[212:215], v[60:63]
  v_mfma_f32_16x16x32_bf16 v[64:67], v[144:147], a[184:187], v[64:67]
  buffer_load_short_d16_hi v181, v4, s[76:79], s12 offen sc1
  s_add_u32 s12, s12, 4096
  v_mfma_f32_16x16x32_bf16 v[68:71], v[148:151], a[184:187], v[68:71]
  v_mfma_f32_16x16x32_bf16 v[72:75], v[152:155], a[184:187], v[72:75]
  ds_write_b128 v13, v[48:51] offset:0
  buffer_load_short_d16_hi v182, v4, s[76:79], s12 offen sc1
  s_add_u32 s12, s12, 4096
  v_mfma_f32_16x16x32_bf16 v[76:79], v[156:159], a[184:187], v[76:79]
  v_mfma_f32_16x16x32_bf16 v[64:67], v[96:99], a[200:203], v[64:67]
  ds_write_b128 v13, v[52:55] offset:1024
  buffer_load_short_d16_hi v183, v4, s[76:79], s12 offen sc1
  s_add_u32 s12, s12, 102400
  v_mfma_f32_16x16x32_bf16 v[68:71], v[100:103], a[200:203], v[68:71]
  v_mfma_f32_16x16x32_bf16 v[72:75], v[104:107], a[200:203], v[72:75]
  ds_write_b128 v13, v[56:59] offset:2048
  buffer_load_short_d16_hi v184, v4, s[76:79], s12 offen sc1
  s_add_u32 s12, s12, 4096
  v_mfma_f32_16x16x32_bf16 v[76:79], v[108:111], a[200:203], v[76:79]
  v_mfma_f32_16x16x32_bf16 v[64:67], v[112:115], a[216:219], v[64:67]
  ds_write_b128 v13, v[60:63] offset:3072
  buffer_load_short_d16_hi v185, v4, s[76:79], s12 offen sc1
  s_add_u32 s12, s12, 4096
  v_mfma_f32_16x16x32_bf16 v[68:71], v[116:119], a[216:219], v[68:71]
  v_mfma_f32_16x16x32_bf16 v[72:75], v[120:123], a[216:219], v[72:75]
  buffer_load_short_d16_hi v186, v4, s[76:79], s12 offen sc1
  s_add_u32 s12, s12, 4096
  v_mfma_f32_16x16x32_bf16 v[76:79], v[124:127], a[216:219], v[76:79]
  v_mfma_f32_16x16x32_bf16 v[80:83], v[144:147], a[188:191], v[80:83]
  buffer_load_short_d16_hi v187, v4, s[76:79], s12 offen sc1
  s_add_u32 s12, s12, 4096
  v_mfma_f32_16x16x32_bf16 v[84:87], v[148:151], a[188:191], v[84:87]
  v_mfma_f32_16x16x32_bf16 v[88:91], v[152:155], a[188:191], v[88:91]
  ds_write_b128 v14, v[64:67] offset:0
  buffer_load_short_d16_hi v188, v4, s[76:79], s12 offen sc1
  s_add_u32 s12, s12, 4096
  v_mfma_f32_16x16x32_bf16 v[92:95], v[156:159], a[188:191], v[92:95]
  v_mfma_f32_16x16x32_bf16 v[80:83], v[96:99], a[204:207], v[80:83]
  ds_write_b128 v14, v[68:71] offset:1024
  buffer_load_short_d16_hi v189, v4, s[76:79], s12 offen sc1
  s_add_u32 s12, s12, 4096
  v_mfma_f32_16x16x32_bf16 v[84:87], v[100:103], a[204:207], v[84:87]
  v_mfma_f32_16x16x32_bf16 v[88:91], v[104:107], a[204:207], v[88:91]
  ds_write_b128 v14, v[72:75] offset:2048
  buffer_load_short_d16_hi v190, v4, s[76:79], s12 offen sc1
  s_add_u32 s12, s12, 4096
  v_mfma_f32_16x16x32_bf16 v[92:95], v[108:111], a[204:207], v[92:95]
  v_mfma_f32_16x16x32_bf16 v[80:83], v[112:115], a[220:223], v[80:83]
  ds_write_b128 v14, v[76:79] offset:3072
  buffer_load_short_d16_hi v191, v4, s[76:79], s12 offen sc1
  v_mfma_f32_16x16x32_bf16 v[84:87], v[116:119], a[220:223], v[84:87]
  v_mfma_f32_16x16x32_bf16 v[88:91], v[120:123], a[220:223], v[88:91]
  v_mfma_f32_16x16x32_bf16 v[92:95], v[124:127], a[220:223], v[92:95]
  s_waitcnt lgkmcnt(0)
  s_barrier
  ds_read_b128 v[112:115], v15 offset:0
  ds_read_b128 v[116:119], v15 offset:1024
  ds_read_b128 v[120:123], v15 offset:2048
  ds_read_b128 v[124:127], v15 offset:3072
  ds_read_b128 v[128:131], v15 offset:4096
  ds_read_b128 v[132:135], v15 offset:5120
  ds_read_b128 v[136:139], v15 offset:6144
  ds_read_b128 v[140:143], v15 offset:7168
  ds_read_b128 v[144:147], v15 offset:8192
  ds_read_b128 v[148:151], v15 offset:9216
  ds_read_b128 v[152:155], v15 offset:10240
  ds_read_b128 v[156:159], v15 offset:11264
  s_waitcnt lgkmcnt(8)
  v_pk_add_f32 v[96:97], v[80:81], v[112:113]
  v_pk_add_f32 v[98:99], v[82:83], v[114:115]
  v_pk_add_f32 v[100:101], v[84:85], v[116:117]
  v_pk_add_f32 v[102:103], v[86:87], v[118:119]
  v_pk_add_f32 v[104:105], v[88:89], v[120:121]
  v_pk_add_f32 v[106:107], v[90:91], v[122:123]
  v_pk_add_f32 v[108:109], v[92:93], v[124:125]
  v_pk_add_f32 v[110:111], v[94:95], v[126:127]
  s_waitcnt lgkmcnt(4)
  v_pk_add_f32 v[96:97], v[96:97], v[128:129]
  v_pk_add_f32 v[98:99], v[98:99], v[130:131]
  v_pk_add_f32 v[100:101], v[100:101], v[132:133]
  v_pk_add_f32 v[102:103], v[102:103], v[134:135]
  v_pk_add_f32 v[104:105], v[104:105], v[136:137]
  v_pk_add_f32 v[106:107], v[106:107], v[138:139]
  v_pk_add_f32 v[108:109], v[108:109], v[140:141]
  v_pk_add_f32 v[110:111], v[110:111], v[142:143]
  s_waitcnt lgkmcnt(0)
  v_pk_add_f32 v[96:97], v[96:97], v[144:145]
  v_pk_add_f32 v[98:99], v[98:99], v[146:147]
  v_pk_add_f32 v[100:101], v[100:101], v[148:149]
  v_pk_add_f32 v[102:103], v[102:103], v[150:151]
  v_pk_add_f32 v[104:105], v[104:105], v[152:153]
  v_pk_add_f32 v[106:107], v[106:107], v[154:155]
  v_pk_add_f32 v[108:109], v[108:109], v[156:157]
  v_pk_add_f32 v[110:111], v[110:111], v[158:159]
  v_cvt_pk_bf16_f32 v96, 0, v96
  v_cvt_pk_bf16_f32 v97, 0, v97
  v_cvt_pk_bf16_f32 v98, 0, v98
  v_cvt_pk_bf16_f32 v99, 0, v99
  v_cvt_pk_bf16_f32 v100, 0, v100
  v_cvt_pk_bf16_f32 v101, 0, v101
  v_cvt_pk_bf16_f32 v102, 0, v102
  v_cvt_pk_bf16_f32 v103, 0, v103
  v_cvt_pk_bf16_f32 v104, 0, v104
  v_cvt_pk_bf16_f32 v105, 0, v105
  v_cvt_pk_bf16_f32 v106, 0, v106
  v_cvt_pk_bf16_f32 v107, 0, v107
  v_cvt_pk_bf16_f32 v108, 0, v108
  v_cvt_pk_bf16_f32 v109, 0, v109
  v_cvt_pk_bf16_f32 v110, 0, v110
  v_cvt_pk_bf16_f32 v111, 0, v111
  v_pk_add_f32 v[96:97], v[96:97], v[28:29] op_sel_hi:[1,0]
  v_pk_add_f32 v[98:99], v[98:99], v[28:29] op_sel_hi:[1,0]
  v_pk_add_f32 v[100:101], v[100:101], v[28:29] op_sel_hi:[1,0]
  v_pk_add_f32 v[102:103], v[102:103], v[28:29] op_sel_hi:[1,0]
  v_pk_add_f32 v[104:105], v[104:105], v[28:29] op_sel_hi:[1,0]
  v_pk_add_f32 v[106:107], v[106:107], v[28:29] op_sel_hi:[1,0]
  v_pk_add_f32 v[108:109], v[108:109], v[28:29] op_sel_hi:[1,0]
  v_pk_add_f32 v[110:111], v[110:111], v[28:29] op_sel_hi:[1,0]
  v_cvt_pk_bf16_f32 v96, 0, v96
  v_cvt_pk_bf16_f32 v97, 0, v97
  v_cvt_pk_bf16_f32 v98, 0, v98
  v_cvt_pk_bf16_f32 v99, 0, v99
  v_cvt_pk_bf16_f32 v100, 0, v100
  v_cvt_pk_bf16_f32 v101, 0, v101
  v_cvt_pk_bf16_f32 v102, 0, v102
  v_cvt_pk_bf16_f32 v103, 0, v103
  v_cvt_pk_bf16_f32 v104, 0, v104
  v_cvt_pk_bf16_f32 v105, 0, v105
  v_cvt_pk_bf16_f32 v106, 0, v106
  v_cvt_pk_bf16_f32 v107, 0, v107
  v_cvt_pk_bf16_f32 v108, 0, v108
  v_cvt_pk_bf16_f32 v109, 0, v109
  v_cvt_pk_bf16_f32 v110, 0, v110
  v_cvt_pk_bf16_f32 v111, 0, v111
  v_pk_mul_f32 v[112:113], v[96:97], v[20:21] op_sel_hi:[1,0]
  v_pk_mul_f32 v[114:115], v[98:99], v[20:21] op_sel_hi:[1,0]
  v_pk_mul_f32 v[116:117], v[100:101], v[20:21] op_sel_hi:[1,0]
  v_pk_mul_f32 v[118:119], v[102:103], v[20:21] op_sel_hi:[1,0]
  v_pk_mul_f32 v[120:121], v[104:105], v[20:21] op_sel_hi:[1,0]
  v_pk_mul_f32 v[122:123], v[106:107], v[20:21] op_sel_hi:[1,0]
  v_pk_mul_f32 v[124:125], v[108:109], v[20:21] op_sel_hi:[1,0]
  v_pk_mul_f32 v[126:127], v[110:111], v[20:21] op_sel_hi:[1,0]
  v_exp_f32 v112, v112
  v_exp_f32 v113, v113
  v_exp_f32 v114, v114
  v_exp_f32 v115, v115
  v_exp_f32 v116, v116
  v_exp_f32 v117, v117
  v_exp_f32 v118, v118
  v_exp_f32 v119, v119
  v_exp_f32 v120, v120
  v_exp_f32 v121, v121
  v_exp_f32 v122, v122
  v_exp_f32 v123, v123
  v_exp_f32 v124, v124
  v_exp_f32 v125, v125
  v_exp_f32 v126, v126
  v_exp_f32 v127, v127
  v_pk_add_f32 v[112:113], v[112:113], 1.0 op_sel_hi:[1,0]
  v_pk_add_f32 v[114:115], v[114:115], 1.0 op_sel_hi:[1,0]
  v_pk_add_f32 v[116:117], v[116:117], 1.0 op_sel_hi:[1,0]
  v_pk_add_f32 v[118:119], v[118:119], 1.0 op_sel_hi:[1,0]
  v_pk_add_f32 v[120:121], v[120:121], 1.0 op_sel_hi:[1,0]
  v_pk_add_f32 v[122:123], v[122:123], 1.0 op_sel_hi:[1,0]
  v_pk_add_f32 v[124:125], v[124:125], 1.0 op_sel_hi:[1,0]
  v_pk_add_f32 v[126:127], v[126:127], 1.0 op_sel_hi:[1,0]
  v_rcp_f32 v112, v112
  v_rcp_f32 v113, v113
  v_rcp_f32 v114, v114
  v_rcp_f32 v115, v115
  v_rcp_f32 v116, v116
  v_rcp_f32 v117, v117
  v_rcp_f32 v118, v118
  v_rcp_f32 v119, v119
  v_rcp_f32 v120, v120
  v_rcp_f32 v121, v121
  v_rcp_f32 v122, v122
  v_rcp_f32 v123, v123
  v_rcp_f32 v124, v124
  v_rcp_f32 v125, v125
  v_rcp_f32 v126, v126
  v_rcp_f32 v127, v127
  v_pk_mul_f32 v[96:97], v[96:97], v[112:113]
  v_pk_mul_f32 v[98:99], v[98:99], v[114:115]
  v_pk_mul_f32 v[100:101], v[100:101], v[116:117]
  v_pk_mul_f32 v[102:103], v[102:103], v[118:119]
  v_cvt_pk_bf16_f32 v128, v96, v97
  v_cvt_pk_bf16_f32 v129, v98, v99
  v_cvt_pk_bf16_f32 v130, v100, v101
  v_cvt_pk_bf16_f32 v131, v102, v103
  s_nop 0
  v_permlane16_swap_b32 v128, v130
  v_permlane16_swap_b32 v129, v131
  v_lshlrev_b32 v96, 16, v128
  v_and_b32 v97, 0xffff0000, v128
  v_lshlrev_b32 v98, 16, v129
  v_and_b32 v99, 0xffff0000, v129
  v_lshlrev_b32 v100, 16, v130
  v_and_b32 v101, 0xffff0000, v130
  v_lshlrev_b32 v102, 16, v131
  v_and_b32 v103, 0xffff0000, v131
  v_pk_mul_f32 v[104:105], v[104:105], v[120:121]
  v_pk_mul_f32 v[106:107], v[106:107], v[122:123]
  v_pk_mul_f32 v[108:109], v[108:109], v[124:125]
  v_pk_mul_f32 v[110:111], v[110:111], v[126:127]
  v_cvt_pk_bf16_f32 v132, v104, v105
  v_cvt_pk_bf16_f32 v133, v106, v107
  v_cvt_pk_bf16_f32 v134, v108, v109
  v_cvt_pk_bf16_f32 v135, v110, v111
  s_nop 0
  v_permlane16_swap_b32 v132, v134
  v_permlane16_swap_b32 v133, v135
  v_lshlrev_b32 v104, 16, v132
  v_and_b32 v105, 0xffff0000, v132
  v_lshlrev_b32 v106, 16, v133
  v_and_b32 v107, 0xffff0000, v133
  v_lshlrev_b32 v108, 16, v134
  v_and_b32 v109, 0xffff0000, v134
  v_lshlrev_b32 v110, 16, v135
  v_and_b32 v111, 0xffff0000, v135
  s_waitcnt vmcnt(0)
  v_pk_mul_f32 v[208:209], v[208:209], v[176:177]
  v_pk_mul_f32 v[210:211], v[210:211], v[178:179]
  v_pk_mul_f32 v[212:213], v[212:213], v[180:181]
  v_pk_mul_f32 v[214:215], v[214:215], v[182:183]
  v_pk_mul_f32 v[216:217], v[216:217], v[184:185]
  v_pk_mul_f32 v[218:219], v[218:219], v[186:187]
  v_pk_mul_f32 v[220:221], v[220:221], v[188:189]
  v_pk_mul_f32 v[222:223], v[222:223], v[190:191]
  v_cvt_pk_bf16_f32 v208, 0, v208
  v_cvt_pk_bf16_f32 v209, 0, v209
  v_cvt_pk_bf16_f32 v210, 0, v210
  v_cvt_pk_bf16_f32 v211, 0, v211
  v_cvt_pk_bf16_f32 v212, 0, v212
  v_cvt_pk_bf16_f32 v213, 0, v213
  v_cvt_pk_bf16_f32 v214, 0, v214
  v_cvt_pk_bf16_f32 v215, 0, v215
  v_cvt_pk_bf16_f32 v216, 0, v216
  v_cvt_pk_bf16_f32 v217, 0, v217
  v_cvt_pk_bf16_f32 v218, 0, v218
  v_cvt_pk_bf16_f32 v219, 0, v219
  v_cvt_pk_bf16_f32 v220, 0, v220
  v_cvt_pk_bf16_f32 v221, 0, v221
  v_cvt_pk_bf16_f32 v222, 0, v222
  v_cvt_pk_bf16_f32 v223, 0, v223
  v_pk_mul_f32 v[96:97], v[96:97], v[208:209]
  v_pk_mul_f32 v[98:99], v[98:99], v[210:211]
  v_pk_mul_f32 v[100:101], v[100:101], v[212:213]
  v_pk_mul_f32 v[102:103], v[102:103], v[214:215]
  v_cvt_pk_bf16_f32 v96, 0, v96
  v_cvt_pk_bf16_f32 v97, 0, v97
  v_cvt_pk_bf16_f32 v98, 0, v98
  v_cvt_pk_bf16_f32 v99, 0, v99
  v_cvt_pk_bf16_f32 v100, 0, v100
  v_cvt_pk_bf16_f32 v101, 0, v101
  v_cvt_pk_bf16_f32 v102, 0, v102
  v_cvt_pk_bf16_f32 v103, 0, v103
  v_pk_add_f32 v[96:97], v[96:97], v[224:225]
  v_pk_add_f32 v[98:99], v[98:99], v[226:227]
  v_pk_add_f32 v[100:101], v[100:101], v[228:229]
  v_pk_add_f32 v[102:103], v[102:103], v[230:231]
  v_cvt_pk_bf16_f32 v128, v96, v97
  v_cvt_pk_bf16_f32 v129, v98, v99
  v_cvt_pk_bf16_f32 v130, v100, v101
  v_cvt_pk_bf16_f32 v131, v102, v103
  buffer_store_dwordx4 v[128:131], v10, s[72:75], s99 offen offset:0 sc1
  v_pk_mul_f32 v[104:105], v[104:105], v[216:217]
  v_pk_mul_f32 v[106:107], v[106:107], v[218:219]
  v_pk_mul_f32 v[108:109], v[108:109], v[220:221]
  v_pk_mul_f32 v[110:111], v[110:111], v[222:223]
  v_cvt_pk_bf16_f32 v104, 0, v104
  v_cvt_pk_bf16_f32 v105, 0, v105
  v_cvt_pk_bf16_f32 v106, 0, v106
  v_cvt_pk_bf16_f32 v107, 0, v107
  v_cvt_pk_bf16_f32 v108, 0, v108
  v_cvt_pk_bf16_f32 v109, 0, v109
  v_cvt_pk_bf16_f32 v110, 0, v110
  v_cvt_pk_bf16_f32 v111, 0, v111
  v_pk_add_f32 v[104:105], v[104:105], v[232:233]
  v_pk_add_f32 v[106:107], v[106:107], v[234:235]
  v_pk_add_f32 v[108:109], v[108:109], v[236:237]
  v_pk_add_f32 v[110:111], v[110:111], v[238:239]
  v_cvt_pk_bf16_f32 v132, v104, v105
  v_cvt_pk_bf16_f32 v133, v106, v107
  v_cvt_pk_bf16_f32 v134, v108, v109
  v_cvt_pk_bf16_f32 v135, v110, v111
  buffer_store_dwordx4 v[132:135], v10, s[72:75], s99 offen offset:64 sc1
  s_or_b32 s8, s2, s80
  s_cmp_lg_u32 s8, 0
  s_cbranch_scc1 L20
  v_mov_b32 v30, s85
  v_mov_b32 v31, 0
  s_mov_b32 s8, 8716288
  s_mov_b64 exec, 1
  buffer_store_dword v30, v31, s[76:79], s8 offen sc1
  s_mov_b64 exec, -1
L20:
ROLEC:
KFLUSH:
Kend:
s_endpgm
KEND:
.section .rodata,"a"
.p2align 6
.amdhsa_kernel recurrent_scan__ssm_conv_h3__mixer_token_mlp__prompt_kernel
  .amdhsa_next_free_vgpr 512
  .amdhsa_next_free_sgpr 102
  .amdhsa_accum_offset 256
  .amdhsa_group_segment_fixed_size 0
  .amdhsa_kernarg_size 112
  .amdhsa_user_sgpr_count 2
  .amdhsa_user_sgpr_kernarg_segment_ptr 1
  .amdhsa_system_sgpr_workgroup_id_x 1
  .amdhsa_float_denorm_mode_32 3
.end_amdhsa_kernel
```
